```python
import torch

def _softmax(x, axis=-1):
    return torch.softmax(x, dim=axis)
def _gelu(x):
    return torch.nn.functional.gelu(x, approximate="tanh")
def _silu(x):
    return torch.nn.functional.silu(x)
def _sigmoid(x):
    return torch.sigmoid(x)
def _layernorm(x, axis=-1, eps=1e-5):
    m = x.mean(dim=axis, keepdim=True)
    v = x.var(dim=axis, keepdim=True, unbiased=False)
    return (x - m) / torch.sqrt(v + eps)
def _scatter_add(tgt, idx, src, axis=0):
    return tgt.clone().index_add_(axis, idx, src)
def _segment_sum(src, seg, n):
    out = torch.zeros((n,) + src.shape[1:], dtype=src.dtype)
    return out.index_add_(0, seg, src)
def _pad(x, pw):
    flat = tuple(v for pair in reversed(pw) for v in pair)
    return torch.nn.functional.pad(x, flat)

kernel_name = 'gated_mix__sliding_block_cached__gqa_block_cached__decode'

def setup_inputs():

    _w = (lambda a: (lambda t: t.to(torch.bfloat16) if t.is_floating_point() else t)(torch.as_tensor(a)))
    def _A_setup():
        B, Sq, D = 2, 1, 576
        Hq, Hkv, Sk, Dh = 32, 16, 8192, 128
        assert Hq % Hkv == 0, (Hq, Hkv)
        return {
            "x": _w((lambda *s: torch.randn(*s, dtype=torch.bfloat16) * 0.05)(B, Sq, D)),
            "k_cache": _w((lambda *s: torch.randn(*s, dtype=torch.bfloat16) * 6.4)(B, Hkv, Sk, Dh)),
            "v_cache": _w((lambda *s: torch.randn(*s, dtype=torch.bfloat16) * 0.05)(B, Hkv, Sk, Dh)),
            "wq": _w((lambda *s: torch.randn(*s, dtype=torch.bfloat16) * 6.4)(D, Hq * Dh) * (D ** -0.5)),
            "wo": _w((lambda *s: torch.randn(*s, dtype=torch.bfloat16) * 0.05)(Hq * Dh, D) * ((Hq * Dh) ** -0.5)),
        }
    _A_in = _A_setup()

    def _B_setup():
        B, Sq, D = 2, 1, 576
        Hq, Hkv, Sk, Dh = 32, 16, 8192, 128
        assert Hq % Hkv == 0, (Hq, Hkv)
        return {
            "x": _w((lambda *s: torch.randn(*s, dtype=torch.bfloat16) * 0.05)(B, Sq, D)),
            "k_cache": _w((lambda *s: torch.randn(*s, dtype=torch.bfloat16) * 6.4)(B, Hkv, Sk, Dh)),
            "v_cache": _w((lambda *s: torch.randn(*s, dtype=torch.bfloat16) * 0.05)(B, Hkv, Sk, Dh)),
            "wq": _w((lambda *s: torch.randn(*s, dtype=torch.bfloat16) * 6.4)(D, Hq * Dh) * (D ** -0.5)),
            "wo": _w((lambda *s: torch.randn(*s, dtype=torch.bfloat16) * 0.05)(Hq * Dh, D) * ((Hq * Dh) ** -0.5)),
        }
    _B_in = _B_setup()

    return {
        "A_x": _A_in["x"],
        "A_k_cache": _A_in["k_cache"],
        "A_v_cache": _A_in["v_cache"],
        "A_wq": _A_in["wq"],
        "A_wo": _A_in["wo"],
        "B_x": _B_in["x"],
        "B_k_cache": _B_in["k_cache"],
        "B_v_cache": _B_in["v_cache"],
        "B_wq": _B_in["wq"],
        "B_wo": _B_in["wo"],
        "gate_w": _w((lambda *s: torch.randn(*s, dtype=torch.bfloat16) * 0.05)(576) * 16.0),
    }

def reference(A_x, A_k_cache, A_v_cache, A_wq, A_wo, B_x, B_k_cache, B_v_cache, B_wq, B_wo, gate_w):
    def _A_ref(x, k_cache, v_cache, wq, wo):
        B, Sq, D = x.shape
        Hq, Dh = 32, 128
        Hkv, Sk = k_cache.shape[1], k_cache.shape[2]
        W = min(4096, max(256, Sk // 4))
        rep = Hq // Hkv
        q = (lambda x, *d: x.permute(*d))((x @ wq).reshape(B, Sq, Hq, Dh), 0, 2, 1, 3)
        k = (lambda x, n, axis: torch.repeat_interleave(x, n, dim=axis))(k_cache[:, :, Sk - W:, :], rep, axis=1)
        v = (lambda x, n, axis: torch.repeat_interleave(x, n, dim=axis))(v_cache[:, :, Sk - W:, :], rep, axis=1)
        scores = torch.einsum("bhqd,bhkd->bhqk", q, k) * (Dh ** -0.5)
        p = _softmax(scores, axis=-1)
        o = torch.einsum("bhqk,bhkd->bhqd", p, v)
        return (lambda x, *d: x.permute(*d))(o, 0, 2, 1, 3).reshape(B, Sq, Hq * Dh) @ wo

    def _B_ref(x, k_cache, v_cache, wq, wo):
        B, Sq, D = x.shape
        Hq, Dh = 32, 128
        Hkv = k_cache.shape[1]
        rep = Hq // Hkv
        q = (lambda x, *d: x.permute(*d))((x @ wq).reshape(B, Sq, Hq, Dh), 0, 2, 1, 3)
        k = (lambda x, n, axis: torch.repeat_interleave(x, n, dim=axis))(k_cache, rep, axis=1)
        v = (lambda x, n, axis: torch.repeat_interleave(x, n, dim=axis))(v_cache, rep, axis=1)
        scores = torch.einsum("bhqd,bhkd->bhqk", q, k) * (Dh ** -0.5)
        p = _softmax(scores, axis=-1)
        o = torch.einsum("bhqk,bhkd->bhqd", p, v)
        return (lambda x, *d: x.permute(*d))(o, 0, 2, 1, 3).reshape(B, Sq, Hq * Dh) @ wo

    x = A_x
    g = _sigmoid((x * gate_w).sum(-1, keepdims=True))
    a = _A_ref(x, A_k_cache, A_v_cache, A_wq, A_wo)
    b = _B_ref(x, B_k_cache, B_v_cache, B_wq, B_wo)
    return g * a + (1 - g) * b
```

```asm
; @launch grid=(256,1,1) block=(384,1,1) lds=22528
.amdgcn_target "amdgcn-amd-amdhsa--gfx950"
.text
.globl gated_mix__sliding_block_cached__gqa_block_cached__decode_kernel
.p2align 8
.type gated_mix__sliding_block_cached__gqa_block_cached__decode_kernel,@function
gated_mix__sliding_block_cached__gqa_block_cached__decode_kernel:
    s_cmp_ge_u32 s2, 256
    s_cbranch_scc1 L_end
    s_load_dwordx16 s[16:31], s[0:1], 0
    s_load_dwordx8 s[32:39], s[0:1], 64
    s_load_dwordx4 s[40:43], s[0:1], 96
    s_mov_b32 s71, s2
    s_and_b32 s5, s2, 15
    s_bfe_u32 s6, s2, 0x30004
    v_lshrrev_b32 v2, 6, v0
    v_and_b32 v1, 63, v0
    v_readfirstlane_b32 s3, v2
    s_lshr_b32 s4, s2, 7
    s_lshl_b32 s7, s4, 4
    s_or_b32 s7, s7, s5
    s_lshl_b32 s2, s7, 3
    s_or_b32 s2, s2, s6
    v_lshrrev_b32 v2, 4, v1
    v_and_b32 v3, 15, v1
    s_cmp_eq_u32 s3, 0
    s_cbranch_scc1 L_h0
    s_cmp_eq_u32 s3, 1
    s_cbranch_scc1 L_h1
L_stream:
    s_sub_u32 s15, s3, 2
    v_lshrrev_b32 v8, 2, v3
    v_lshlrev_b32 v8, 8, v8
    v_lshl_add_u32 v8, v2, 6, v8
    v_and_b32 v9, 3, v1
    v_lshl_add_u32 v8, v9, 4, v8
    v_lshlrev_b32 v60, 4, v1
    s_lshl_b32 s12, s6, 2
    s_add_u32 s12, s12, s15
    s_lshl_b32 s68, s12, 12
    s_lshl_b32 s13, s7, 21
    s_lshl_b32 s14, s5, 17
    s_or_b32 s91, s13, s14
    s_or_b32 s90, s91, 0x180000
    s_mov_b32 s46, 0x4000000
    s_mov_b32 s47, 0x20000
    s_mov_b64 s[50:51], s[46:47]
    s_waitcnt lgkmcnt(0)
    s_mov_b64 s[44:45], s[18:19]
    s_mov_b64 s[48:49], s[20:21]
    s_xor_b32 s93, s68, s90
    buffer_load_dwordx4 v[128:131], v8, s[44:47], s93 offen offset:0 nt
    buffer_load_dwordx4 v[132:135], v8, s[44:47], s93 offen offset:1024 nt
    buffer_load_dwordx4 v[136:139], v8, s[44:47], s93 offen offset:2048 nt
    buffer_load_dwordx4 v[140:143], v8, s[44:47], s93 offen offset:3072 nt
    buffer_load_dwordx4 v[144:147], v60, s[48:51], s93 offen offset:0 nt
    s_branch L_stream2
L_h0:
    s_setprio 3
    s_lshr_b32 s8, s6, 2
    s_and_b32 s9, s6, 3
    v_lshrrev_b32 v8, 3, v3
    v_mul_u32_u24 v8, 1152, v8
    v_mul_u32_u24 v9, 72, v2
    s_mul_i32 s11, s9, 288
    v_add3_u32 v8, v8, v9, s11
    v_mul_u32_u24 v9, 0x48000, v2
    v_lshl_add_u32 v9, v3, 4, v9
    s_mul_i32 s11, s9, 0x120000
    s_lshl_b32 s12, s5, 9
    s_lshl_b32 s13, s8, 8
    s_add_u32 s11, s11, s12
    s_add_u32 s11, s11, s13
    s_mov_b32 s62, 0x480000
    s_mov_b32 s63, 0x20000
    s_cmp_eq_u32 s4, 0
    s_waitcnt lgkmcnt(0)
    s_cselect_b64 s[60:61], s[22:23], s[32:33]
    buffer_load_dwordx4 v[64:67], v9, s[60:63], s11 offen nt
    s_addk_i32 s11, 0x2000
    buffer_load_dwordx4 v[68:71], v9, s[60:63], s11 offen nt
    s_addk_i32 s11, 0x2000
    buffer_load_dwordx4 v[72:75], v9, s[60:63], s11 offen nt
    s_addk_i32 s11, 0x2000
    buffer_load_dwordx4 v[76:79], v9, s[60:63], s11 offen nt
    s_addk_i32 s11, 0x2000
    buffer_load_dwordx4 v[80:83], v9, s[60:63], s11 offen nt
    s_addk_i32 s11, 0x2000
    buffer_load_dwordx4 v[84:87], v9, s[60:63], s11 offen nt
    s_addk_i32 s11, 0x2000
    buffer_load_dwordx4 v[88:91], v9, s[60:63], s11 offen nt
    s_addk_i32 s11, 0x2000
    buffer_load_dwordx4 v[92:95], v9, s[60:63], s11 offen nt
    s_addk_i32 s11, 0x2000
    buffer_load_dwordx4 v[96:99], v9, s[60:63], s11 offen nt
    s_addk_i32 s11, 0x2000
    buffer_load_dwordx4 v[100:103], v9, s[60:63], s11 offen nt
    s_addk_i32 s11, 0x2000
    buffer_load_dwordx4 v[104:107], v9, s[60:63], s11 offen nt
    s_addk_i32 s11, 0x2000
    buffer_load_dwordx4 v[108:111], v9, s[60:63], s11 offen nt
    s_addk_i32 s11, 0x2000
    buffer_load_dwordx4 v[112:115], v9, s[60:63], s11 offen nt
    s_addk_i32 s11, 0x2000
    buffer_load_dwordx4 v[116:119], v9, s[60:63], s11 offen nt
    s_addk_i32 s11, 0x2000
    buffer_load_dwordx4 v[120:123], v9, s[60:63], s11 offen nt
    s_addk_i32 s11, 0x2000
    buffer_load_dwordx4 v[124:127], v9, s[60:63], s11 offen nt
    s_addk_i32 s11, 0x2000
    global_load_dwordx4 v[16:19], v8, s[16:17]
    global_load_dwordx4 v[20:23], v8, s[16:17] offset:16
    global_load_dwordx4 v[24:27], v8, s[16:17] offset:32
    global_load_dwordx4 v[28:31], v8, s[16:17] offset:48
    global_load_dwordx2 v[32:33], v8, s[16:17] offset:64
    buffer_load_dwordx4 v[128:131], v9, s[60:63], s11 offen nt
    s_addk_i32 s11, 0x2000
    buffer_load_dwordx4 v[132:135], v9, s[60:63], s11 offen nt
    s_addk_i32 s11, 0x2000
    buffer_load_dwordx4 v[136:139], v9, s[60:63], s11 offen nt
    s_addk_i32 s11, 0x2000
    buffer_load_dwordx4 v[140:143], v9, s[60:63], s11 offen nt
    s_addk_i32 s11, 0x2000
    buffer_load_dwordx4 v[144:147], v9, s[60:63], s11 offen nt
    s_addk_i32 s11, 0x2000
    buffer_load_dwordx4 v[148:151], v9, s[60:63], s11 offen nt
    s_addk_i32 s11, 0x2000
    buffer_load_dwordx4 v[152:155], v9, s[60:63], s11 offen nt
    s_addk_i32 s11, 0x2000
    buffer_load_dwordx4 v[156:159], v9, s[60:63], s11 offen nt
    s_addk_i32 s11, 0x2000
    buffer_load_dwordx4 v[160:163], v9, s[60:63], s11 offen nt
    s_addk_i32 s11, 0x2000
    buffer_load_dwordx4 v[164:167], v9, s[60:63], s11 offen nt
    s_addk_i32 s11, 0x2000
    buffer_load_dwordx4 v[168:171], v9, s[60:63], s11 offen nt
    s_addk_i32 s11, 0x2000
    buffer_load_dwordx4 v[172:175], v9, s[60:63], s11 offen nt
    s_addk_i32 s11, 0x2000
    buffer_load_dwordx4 v[176:179], v9, s[60:63], s11 offen nt
    s_addk_i32 s11, 0x2000
    buffer_load_dwordx4 v[180:183], v9, s[60:63], s11 offen nt
    s_addk_i32 s11, 0x2000
    buffer_load_dwordx4 v[184:187], v9, s[60:63], s11 offen nt
    s_addk_i32 s11, 0x2000
    buffer_load_dwordx4 v[188:191], v9, s[60:63], s11 offen nt
    s_addk_i32 s11, 0x2000
    buffer_load_dwordx4 v[192:195], v9, s[60:63], s11 offen nt
    s_addk_i32 s11, 0x2000
    buffer_load_dwordx4 v[196:199], v9, s[60:63], s11 offen nt
    s_addk_i32 s11, 0x2000
    buffer_load_dwordx4 v[200:203], v9, s[60:63], s11 offen nt
    s_addk_i32 s11, 0x2000
    buffer_load_dwordx4 v[204:207], v9, s[60:63], s11 offen nt
    s_barrier
    s_load_dwordx2 s[88:89], s[42:43], 0xf0000
    s_mul_i32 s12, s7, 17408
    s_add_u32 s12, s12, 1572864
    v_and_b32 v10, 3, v1
    v_mul_u32_u24 v10, 4352, v10
    v_add_u32 v10, s12, v10
    v_mov_b32 v11, 0
    s_cmp_lg_u32 s6, 0
    s_cbranch_scc1 L_nozero
    s_mov_b64 exec, 15
    global_store_dword v10, v11, s[42:43] sc1
    s_mov_b64 exec, -1
L_nozero:
    v_and_b32 v13, 1, v1
    v_lshlrev_b32 v13, 4, v13
    v_mov_b32 v14, 0xffff
    v_lshlrev_b32 v13, v13, v14
    v_bfe_u32 v14, v1, 1, 2
    v_cmp_eq_u32 vcc, 0, v14
    v_cmp_eq_u32 s[100:101], 1, v14
    v_mov_b32 v62, 0x3ff
    v_cndmask_b32 v4, 0, v13, vcc
    v_cndmask_b32 v5, 0, v13, s[100:101]
    v_cmp_eq_u32 vcc, 2, v14
    v_cmp_eq_u32 s[100:101], 3, v14
    v_lshlrev_b32 v60, 4, v1
    v_cndmask_b32 v6, 0, v13, vcc
    v_cndmask_b32 v7, 0, v13, s[100:101]
    v_mov_b32 v63, 1024
    s_lshl_b32 s12, s5, 4
    s_lshl_b32 s13, s4, 3
    s_add_u32 s12, s12, s13
    s_add_u32 s12, s12, s6
    s_lshl_b32 s12, s12, 10
    v_add_u32 v48, s12, v60
    v_lshrrev_b32 v8, 5, v1
    v_lshlrev_b32 v49, 12, v8
    v_and_b32 v9, 31, v1
    v_lshl_add_u32 v49, v9, 4, v49
    s_lshl_b32 s13, s5, 14
    s_lshl_b32 s14, s4, 9
    s_add_u32 s13, s13, s14
    v_add_u32 v49, s13, v49
    v_add_u32 v50, 8192, v49
    v_lshlrev_b32 v51, 8, v8
    v_lshl_add_u32 v51, v3, 4, v51
    v_and_b32 v10, 1, v2
    v_lshl_add_u32 v51, v10, 3, v51
    s_mul_i32 s12, s2, 1152
    s_add_u32 s12, s12, 262144
    v_add_u32 v52, s12, v60
    v_lshrrev_b32 v8, 3, v3
    v_lshl_add_u32 v54, v8, 4, s12
    v_lshlrev_b32 v61, 3, v1
    s_mov_b32 s12, 0x01000100
    s_mov_b32 s13, 0x03020302
    s_getreg_b32 s69, hwreg(HW_REG_XCC_ID, 0, 3)
    s_waitcnt lgkmcnt(0)
    s_add_u32 s88, s88, 1
    s_mul_i32 s96, s88, 0x9E3779B1
    s_xor_b32 s96, s96, 0x5BD1E995
    s_lshr_b32 s99, s96, 30
    s_lshl_b32 s97, s89, 2
    s_or_b32 s99, s99, s97
    s_lshl_b32 s99, s99, 3
    s_xor_b32 s99, s99, s96
    s_bfe_u32 s97, s96, 0xa000a
    s_bfe_u32 s98, s96, 0xa0014
    s_and_b32 s96, s96, 0x3ff
    s_and_b32 s99, s99, 0x3ff
    s_andn2_b32 s70, s99, 7
    s_or_b32 s70, s70, s69
    s_waitcnt vmcnt(20)
    v_perm_b32 v34, v16, v16, s12
    v_and_b32 v40, v34, v4
    v_and_b32 v41, v34, v5
    v_and_b32 v42, v34, v6
    v_and_b32 v43, v34, v7
    s_waitcnt vmcnt(35)
    s_nop 0
    v_mfma_f32_16x16x32_bf16 v[36:39], v[40:43], v[64:67], 0
    v_perm_b32 v34, v16, v16, s13
    v_and_b32 v44, v34, v4
    v_and_b32 v45, v34, v5
    v_and_b32 v46, v34, v6
    v_and_b32 v47, v34, v7
    s_waitcnt vmcnt(34)
    s_nop 0
    v_mfma_f32_16x16x32_bf16 v[36:39], v[44:47], v[68:71], v[36:39]
    v_perm_b32 v34, v17, v17, s12
    v_and_b32 v40, v34, v4
    v_and_b32 v41, v34, v5
    v_and_b32 v42, v34, v6
    v_and_b32 v43, v34, v7
    s_waitcnt vmcnt(33)
    s_nop 0
    v_mfma_f32_16x16x32_bf16 v[36:39], v[40:43], v[72:75], v[36:39]
    v_perm_b32 v34, v17, v17, s13
    v_and_b32 v44, v34, v4
    v_and_b32 v45, v34, v5
    v_and_b32 v46, v34, v6
    v_and_b32 v47, v34, v7
    s_waitcnt vmcnt(32)
    s_nop 0
    v_mfma_f32_16x16x32_bf16 v[36:39], v[44:47], v[76:79], v[36:39]
    v_perm_b32 v34, v18, v18, s12
    v_and_b32 v40, v34, v4
    v_and_b32 v41, v34, v5
    v_and_b32 v42, v34, v6
    v_and_b32 v43, v34, v7
    s_waitcnt vmcnt(31)
    s_nop 0
    v_mfma_f32_16x16x32_bf16 v[36:39], v[40:43], v[80:83], v[36:39]
    v_perm_b32 v34, v18, v18, s13
    v_and_b32 v44, v34, v4
    v_and_b32 v45, v34, v5
    v_and_b32 v46, v34, v6
    v_and_b32 v47, v34, v7
    s_waitcnt vmcnt(30)
    s_nop 0
    v_mfma_f32_16x16x32_bf16 v[36:39], v[44:47], v[84:87], v[36:39]
    v_perm_b32 v34, v19, v19, s12
    v_and_b32 v40, v34, v4
    v_and_b32 v41, v34, v5
    v_and_b32 v42, v34, v6
    v_and_b32 v43, v34, v7
    s_waitcnt vmcnt(29)
    s_nop 0
    v_mfma_f32_16x16x32_bf16 v[36:39], v[40:43], v[88:91], v[36:39]
    v_perm_b32 v34, v19, v19, s13
    v_and_b32 v44, v34, v4
    v_and_b32 v45, v34, v5
    v_and_b32 v46, v34, v6
    v_and_b32 v47, v34, v7
    s_waitcnt vmcnt(28)
    s_nop 0
    v_mfma_f32_16x16x32_bf16 v[36:39], v[44:47], v[92:95], v[36:39]
    v_perm_b32 v34, v20, v20, s12
    v_and_b32 v40, v34, v4
    v_and_b32 v41, v34, v5
    v_and_b32 v42, v34, v6
    v_and_b32 v43, v34, v7
    s_waitcnt vmcnt(27)
    s_nop 0
    v_mfma_f32_16x16x32_bf16 v[36:39], v[40:43], v[96:99], v[36:39]
    v_perm_b32 v34, v20, v20, s13
    v_and_b32 v44, v34, v4
    v_and_b32 v45, v34, v5
    v_and_b32 v46, v34, v6
    v_and_b32 v47, v34, v7
    s_waitcnt vmcnt(26)
    s_nop 0
    v_mfma_f32_16x16x32_bf16 v[36:39], v[44:47], v[100:103], v[36:39]
    v_perm_b32 v34, v21, v21, s12
    v_and_b32 v40, v34, v4
    v_and_b32 v41, v34, v5
    v_and_b32 v42, v34, v6
    v_and_b32 v43, v34, v7
    s_waitcnt vmcnt(25)
    s_nop 0
    v_mfma_f32_16x16x32_bf16 v[36:39], v[40:43], v[104:107], v[36:39]
    v_perm_b32 v34, v21, v21, s13
    v_and_b32 v44, v34, v4
    v_and_b32 v45, v34, v5
    v_and_b32 v46, v34, v6
    v_and_b32 v47, v34, v7
    s_waitcnt vmcnt(24)
    s_nop 0
    v_mfma_f32_16x16x32_bf16 v[36:39], v[44:47], v[108:111], v[36:39]
    v_perm_b32 v34, v22, v22, s12
    v_and_b32 v40, v34, v4
    v_and_b32 v41, v34, v5
    v_and_b32 v42, v34, v6
    v_and_b32 v43, v34, v7
    s_waitcnt vmcnt(23)
    s_nop 0
    v_mfma_f32_16x16x32_bf16 v[36:39], v[40:43], v[112:115], v[36:39]
    v_perm_b32 v34, v22, v22, s13
    v_and_b32 v44, v34, v4
    v_and_b32 v45, v34, v5
    v_and_b32 v46, v34, v6
    v_and_b32 v47, v34, v7
    s_waitcnt vmcnt(22)
    s_nop 0
    v_mfma_f32_16x16x32_bf16 v[36:39], v[44:47], v[116:119], v[36:39]
    v_perm_b32 v34, v23, v23, s12
    v_and_b32 v40, v34, v4
    v_and_b32 v41, v34, v5
    v_and_b32 v42, v34, v6
    v_and_b32 v43, v34, v7
    s_waitcnt vmcnt(21)
    s_nop 0
    v_mfma_f32_16x16x32_bf16 v[36:39], v[40:43], v[120:123], v[36:39]
    v_perm_b32 v34, v23, v23, s13
    v_and_b32 v44, v34, v4
    v_and_b32 v45, v34, v5
    v_and_b32 v46, v34, v6
    v_and_b32 v47, v34, v7
    s_waitcnt vmcnt(20)
    s_nop 0
    v_mfma_f32_16x16x32_bf16 v[36:39], v[44:47], v[124:127], v[36:39]
    v_perm_b32 v34, v24, v24, s12
    v_and_b32 v40, v34, v4
    v_and_b32 v41, v34, v5
    v_and_b32 v42, v34, v6
    v_and_b32 v43, v34, v7
    s_waitcnt vmcnt(19)
    s_nop 0
    v_mfma_f32_16x16x32_bf16 v[36:39], v[40:43], v[128:131], v[36:39]
    v_perm_b32 v34, v24, v24, s13
    v_and_b32 v44, v34, v4
    v_and_b32 v45, v34, v5
    v_and_b32 v46, v34, v6
    v_and_b32 v47, v34, v7
    s_waitcnt vmcnt(18)
    s_nop 0
    v_mfma_f32_16x16x32_bf16 v[36:39], v[44:47], v[132:135], v[36:39]
    v_perm_b32 v34, v25, v25, s12
    v_and_b32 v40, v34, v4
    v_and_b32 v41, v34, v5
    v_and_b32 v42, v34, v6
    v_and_b32 v43, v34, v7
    s_waitcnt vmcnt(17)
    s_nop 0
    v_mfma_f32_16x16x32_bf16 v[36:39], v[40:43], v[136:139], v[36:39]
    v_perm_b32 v34, v25, v25, s13
    v_and_b32 v44, v34, v4
    v_and_b32 v45, v34, v5
    v_and_b32 v46, v34, v6
    v_and_b32 v47, v34, v7
    s_waitcnt vmcnt(16)
    s_nop 0
    v_mfma_f32_16x16x32_bf16 v[36:39], v[44:47], v[140:143], v[36:39]
    v_perm_b32 v34, v26, v26, s12
    v_and_b32 v40, v34, v4
    v_and_b32 v41, v34, v5
    v_and_b32 v42, v34, v6
    v_and_b32 v43, v34, v7
    s_waitcnt vmcnt(15)
    s_nop 0
    v_mfma_f32_16x16x32_bf16 v[36:39], v[40:43], v[144:147], v[36:39]
    v_perm_b32 v34, v26, v26, s13
    v_and_b32 v44, v34, v4
    v_and_b32 v45, v34, v5
    v_and_b32 v46, v34, v6
    v_and_b32 v47, v34, v7
    s_waitcnt vmcnt(14)
    s_nop 0
    v_mfma_f32_16x16x32_bf16 v[36:39], v[44:47], v[148:151], v[36:39]
    v_perm_b32 v34, v27, v27, s12
    v_and_b32 v40, v34, v4
    v_and_b32 v41, v34, v5
    v_and_b32 v42, v34, v6
    v_and_b32 v43, v34, v7
    s_waitcnt vmcnt(13)
    s_nop 0
    v_mfma_f32_16x16x32_bf16 v[36:39], v[40:43], v[152:155], v[36:39]
    v_perm_b32 v34, v27, v27, s13
    v_and_b32 v44, v34, v4
    v_and_b32 v45, v34, v5
    v_and_b32 v46, v34, v6
    v_and_b32 v47, v34, v7
    s_waitcnt vmcnt(12)
    s_nop 0
    v_mfma_f32_16x16x32_bf16 v[36:39], v[44:47], v[156:159], v[36:39]
    v_perm_b32 v34, v28, v28, s12
    v_and_b32 v40, v34, v4
    v_and_b32 v41, v34, v5
    v_and_b32 v42, v34, v6
    v_and_b32 v43, v34, v7
    s_waitcnt vmcnt(11)
    s_nop 0
    v_mfma_f32_16x16x32_bf16 v[36:39], v[40:43], v[160:163], v[36:39]
    v_perm_b32 v34, v28, v28, s13
    v_and_b32 v44, v34, v4
    v_and_b32 v45, v34, v5
    v_and_b32 v46, v34, v6
    v_and_b32 v47, v34, v7
    s_waitcnt vmcnt(10)
    s_nop 0
    v_mfma_f32_16x16x32_bf16 v[36:39], v[44:47], v[164:167], v[36:39]
    v_perm_b32 v34, v29, v29, s12
    v_and_b32 v40, v34, v4
    v_and_b32 v41, v34, v5
    v_and_b32 v42, v34, v6
    v_and_b32 v43, v34, v7
    s_waitcnt vmcnt(9)
    s_nop 0
    v_mfma_f32_16x16x32_bf16 v[36:39], v[40:43], v[168:171], v[36:39]
    v_perm_b32 v34, v29, v29, s13
    v_and_b32 v44, v34, v4
    v_and_b32 v45, v34, v5
    v_and_b32 v46, v34, v6
    v_and_b32 v47, v34, v7
    s_waitcnt vmcnt(8)
    s_nop 0
    v_mfma_f32_16x16x32_bf16 v[36:39], v[44:47], v[172:175], v[36:39]
    v_perm_b32 v34, v30, v30, s12
    v_and_b32 v40, v34, v4
    v_and_b32 v41, v34, v5
    v_and_b32 v42, v34, v6
    v_and_b32 v43, v34, v7
    s_waitcnt vmcnt(7)
    s_nop 0
    v_mfma_f32_16x16x32_bf16 v[36:39], v[40:43], v[176:179], v[36:39]
    v_perm_b32 v34, v30, v30, s13
    v_and_b32 v44, v34, v4
    v_and_b32 v45, v34, v5
    v_and_b32 v46, v34, v6
    v_and_b32 v47, v34, v7
    s_waitcnt vmcnt(6)
    s_nop 0
    v_mfma_f32_16x16x32_bf16 v[36:39], v[44:47], v[180:183], v[36:39]
    v_perm_b32 v34, v31, v31, s12
    v_and_b32 v40, v34, v4
    v_and_b32 v41, v34, v5
    v_and_b32 v42, v34, v6
    v_and_b32 v43, v34, v7
    s_waitcnt vmcnt(5)
    s_nop 0
    v_mfma_f32_16x16x32_bf16 v[36:39], v[40:43], v[184:187], v[36:39]
    v_perm_b32 v34, v31, v31, s13
    v_and_b32 v44, v34, v4
    v_and_b32 v45, v34, v5
    v_and_b32 v46, v34, v6
    v_and_b32 v47, v34, v7
    s_waitcnt vmcnt(4)
    s_nop 0
    v_mfma_f32_16x16x32_bf16 v[36:39], v[44:47], v[188:191], v[36:39]
    v_perm_b32 v34, v32, v32, s12
    v_and_b32 v40, v34, v4
    v_and_b32 v41, v34, v5
    v_and_b32 v42, v34, v6
    v_and_b32 v43, v34, v7
    s_waitcnt vmcnt(3)
    s_nop 0
    v_mfma_f32_16x16x32_bf16 v[36:39], v[40:43], v[192:195], v[36:39]
    v_perm_b32 v34, v32, v32, s13
    v_and_b32 v44, v34, v4
    v_and_b32 v45, v34, v5
    v_and_b32 v46, v34, v6
    v_and_b32 v47, v34, v7
    s_waitcnt vmcnt(2)
    s_nop 0
    v_mfma_f32_16x16x32_bf16 v[36:39], v[44:47], v[196:199], v[36:39]
    v_perm_b32 v34, v33, v33, s12
    v_and_b32 v40, v34, v4
    v_and_b32 v41, v34, v5
    v_and_b32 v42, v34, v6
    v_and_b32 v43, v34, v7
    s_waitcnt vmcnt(1)
    s_nop 0
    v_mfma_f32_16x16x32_bf16 v[36:39], v[40:43], v[200:203], v[36:39]
    v_perm_b32 v34, v33, v33, s13
    v_and_b32 v44, v34, v4
    v_and_b32 v45, v34, v5
    v_and_b32 v46, v34, v6
    v_and_b32 v47, v34, v7
    s_waitcnt vmcnt(0)
    s_nop 0
    v_mfma_f32_16x16x32_bf16 v[36:39], v[44:47], v[204:207], v[36:39]
    s_mov_b32 s68, 0
    s_movk_i32 s14, 0x200
    s_nop 5
    v_add_u32 v36, s14, v36
    v_add_u32 v37, s14, v37
    v_add_u32 v38, s14, v38
    v_add_u32 v39, s14, v39
    v_bfi_b32 v36, v62, s96, v36
    v_bfi_b32 v37, v62, s97, v37
    v_bfi_b32 v38, v62, s98, v38
    v_bfi_b32 v39, v62, s70, v39
    global_store_dwordx4 v48, v[36:39], s[42:43]
    s_mov_b32 s11, 262144
L_pq:
    s_sleep 8
    global_load_dwordx4 v[64:67], v49, s[42:43] offset:0 sc1
    global_load_dwordx4 v[68:71], v49, s[42:43] offset:1024 sc1
    global_load_dwordx4 v[72:75], v49, s[42:43] offset:2048 sc1
    global_load_dwordx4 v[76:79], v49, s[42:43] offset:3072 sc1
    global_load_dwordx4 v[80:83], v50, s[42:43] offset:0 sc1
    global_load_dwordx4 v[84:87], v50, s[42:43] offset:1024 sc1
    global_load_dwordx4 v[88:91], v50, s[42:43] offset:2048 sc1
    global_load_dwordx4 v[92:95], v50, s[42:43] offset:3072 sc1
    s_waitcnt vmcnt(7)
    v_xor_b32 v64, s96, v64
    v_xor_b32 v65, s97, v65
    v_xor_b32 v66, s98, v66
    v_xor_b32 v67, s70, v67
    v_or3_b32 v13, v64, v65, v66
    v_mov_b32 v14, v67
    s_waitcnt vmcnt(6)
    v_xor_b32 v68, s96, v68
    v_xor_b32 v69, s97, v69
    v_xor_b32 v70, s98, v70
    v_xor_b32 v71, s70, v71
    v_or3_b32 v13, v13, v68, v69
    v_or_b32 v13, v13, v70
    v_or_b32 v14, v14, v71
    s_waitcnt vmcnt(5)
    v_xor_b32 v72, s96, v72
    v_xor_b32 v73, s97, v73
    v_xor_b32 v74, s98, v74
    v_xor_b32 v75, s70, v75
    v_or3_b32 v13, v13, v72, v73
    v_or_b32 v13, v13, v74
    v_or_b32 v14, v14, v75
    s_waitcnt vmcnt(4)
    v_xor_b32 v76, s96, v76
    v_xor_b32 v77, s97, v77
    v_xor_b32 v78, s98, v78
    v_xor_b32 v79, s70, v79
    v_or3_b32 v13, v13, v76, v77
    v_or_b32 v13, v13, v78
    v_or_b32 v14, v14, v79
    s_waitcnt vmcnt(3)
    v_xor_b32 v80, s96, v80
    v_xor_b32 v81, s97, v81
    v_xor_b32 v82, s98, v82
    v_xor_b32 v83, s70, v83
    v_or3_b32 v13, v13, v80, v81
    v_or_b32 v13, v13, v82
    v_or_b32 v14, v14, v83
    s_waitcnt vmcnt(2)
    v_xor_b32 v84, s96, v84
    v_xor_b32 v85, s97, v85
    v_xor_b32 v86, s98, v86
    v_xor_b32 v87, s70, v87
    v_or3_b32 v13, v13, v84, v85
    v_or_b32 v13, v13, v86
    v_or_b32 v14, v14, v87
    s_waitcnt vmcnt(1)
    v_xor_b32 v88, s96, v88
    v_xor_b32 v89, s97, v89
    v_xor_b32 v90, s98, v90
    v_xor_b32 v91, s70, v91
    v_or3_b32 v13, v13, v88, v89
    v_or_b32 v13, v13, v90
    v_or_b32 v14, v14, v91
    s_waitcnt vmcnt(0)
    v_xor_b32 v92, s96, v92
    v_xor_b32 v93, s97, v93
    v_xor_b32 v94, s98, v94
    v_xor_b32 v95, s70, v95
    v_or3_b32 v13, v13, v92, v93
    v_or_b32 v13, v13, v94
    v_or_b32 v14, v14, v95
    v_and_b32 v15, -8, v14
    v_or_b32 v13, v13, v15
    v_and_b32 v13, v13, v62
    v_cmp_ne_u32 vcc, 0, v13
    s_cbranch_vccz L_pqd
    s_cmp_lg_u32 s11, 262137
    s_cbranch_scc1 L_pqn
    global_store_dwordx4 v48, v[36:39], s[42:43] sc1
L_pqn:
    s_sub_u32 s11, s11, 1
    s_cmp_lg_u32 s11, 0
    s_cbranch_scc1 L_pq
L_pqd:
    v_add_f32 v64, v64, v68
    v_add_f32 v72, v72, v76
    v_add_f32 v65, v65, v69
    v_add_f32 v73, v73, v77
    v_add_f32 v66, v66, v70
    v_add_f32 v74, v74, v78
    v_add_f32 v67, v67, v71
    v_add_f32 v75, v75, v79
    v_add_f32 v64, v64, v72
    v_add_f32 v65, v65, v73
    v_add_f32 v66, v66, v74
    v_add_f32 v67, v67, v75
    v_cvt_pk_bf16_f32 v64, v64, v65
    v_cvt_pk_bf16_f32 v65, v66, v67
    ds_write_b64 v51, v[64:65] offset:0
    v_add_f32 v80, v80, v84
    v_add_f32 v88, v88, v92
    v_add_f32 v81, v81, v85
    v_add_f32 v89, v89, v93
    v_add_f32 v82, v82, v86
    v_add_f32 v90, v90, v94
    v_add_f32 v83, v83, v87
    v_add_f32 v91, v91, v95
    v_add_f32 v80, v80, v88
    v_add_f32 v81, v81, v89
    v_add_f32 v82, v82, v90
    v_add_f32 v83, v83, v91
    v_cvt_pk_bf16_f32 v80, v80, v81
    v_cvt_pk_bf16_f32 v81, v82, v83
    ds_write_b64 v51, v[80:81] offset:512
    v_and_b32 v14, 7, v14
    v_cmp_ne_u32 vcc, 0, v14
    v_mov_b32 v8, 1
    s_waitcnt lgkmcnt(0)
    ds_write_b32 v63, v8 offset:4
    s_mov_b32 s69, 0
    s_cbranch_vccz L_same
    s_mov_b32 s69, 1
    global_store_dwordx4 v48, v[36:39], s[42:43] sc1
L_same:
    v_mov_b32 v42, s98
    v_mov_b32 v43, s99
    s_mov_b32 s10, 0x3fb8aa3b
    s_mov_b32 s11, 2097152
L_lw_a:
    ds_read_b32 v13, v63 offset:8
    s_waitcnt lgkmcnt(0)
    v_cmp_gt_u32 vcc, 28, v13
    s_cbranch_vccz L_lwd_a
    s_sleep 8
    s_sub_u32 s11, s11, 1
    s_cmp_lg_u32 s11, 0
    s_cbranch_scc1 L_lw_a
L_lwd_a:
    s_mov_b32 s11, 2097152
L_lw_a2:
    ds_read_b32 v13, v63 offset:0
    s_waitcnt lgkmcnt(0)
    v_cmp_gt_u32 vcc, 4, v13
    s_cbranch_vccz L_lwd_a2
    s_sleep 8
    s_sub_u32 s11, s11, 1
    s_cmp_lg_u32 s11, 0
    s_cbranch_scc1 L_lw_a2
L_lwd_a2:
    s_branch L_comb
L_combb:
    s_barrier
L_comb:
    ds_read_b64 v[16:17], v61 offset:2048
    ds_read_b64 v[18:19], v61 offset:2560
    ds_read_b64 v[20:21], v61 offset:3072
    ds_read_b64 v[22:23], v61 offset:3584
    ds_read_b128 v[24:27], v60 offset:6144
    ds_read_b128 v[28:31], v60 offset:7168
    ds_read_b128 v[32:35], v60 offset:8192
    ds_read_b128 v[36:39], v60 offset:9216
    s_waitcnt lgkmcnt(4)
    v_max3_f32 v40, v16, v18, v20
    v_max_f32 v40, v40, v22
    v_sub_f32 v16, v16, v40
    v_sub_f32 v18, v18, v40
    v_sub_f32 v20, v20, v40
    v_sub_f32 v22, v22, v40
    v_mul_f32 v16, s10, v16
    v_mul_f32 v18, s10, v18
    v_mul_f32 v20, s10, v20
    v_mul_f32 v22, s10, v22
    v_exp_f32 v16, v16
    v_exp_f32 v18, v18
    v_exp_f32 v20, v20
    v_exp_f32 v22, v22
    v_bfi_b32 v40, v62, s96, v40
    v_mul_f32 v41, v17, v16
    v_fmac_f32 v41, v19, v18
    v_fmac_f32 v41, v21, v20
    v_fmac_f32 v41, v23, v22
    s_cmp_eq_u32 s69, 0
    s_waitcnt lgkmcnt(0)
    v_pk_mul_f32 v[24:25], v[24:25], v[16:17] op_sel_hi:[1,0]
    v_pk_mul_f32 v[26:27], v[26:27], v[16:17] op_sel_hi:[1,0]
    v_pk_fma_f32 v[24:25], v[28:29], v[18:19], v[24:25] op_sel_hi:[1,0,1]
    v_pk_fma_f32 v[26:27], v[30:31], v[18:19], v[26:27] op_sel_hi:[1,0,1]
    v_pk_fma_f32 v[24:25], v[32:33], v[20:21], v[24:25] op_sel_hi:[1,0,1]
    v_pk_fma_f32 v[26:27], v[34:35], v[20:21], v[26:27] op_sel_hi:[1,0,1]
    v_pk_fma_f32 v[24:25], v[36:37], v[22:23], v[24:25] op_sel_hi:[1,0,1]
    v_pk_fma_f32 v[26:27], v[38:39], v[22:23], v[26:27] op_sel_hi:[1,0,1]
    v_bfi_b32 v41, v62, s97, v41
    v_bfi_b32 v24, v62, s96, v24
    v_bfi_b32 v25, v62, s97, v25
    v_bfi_b32 v26, v62, s98, v26
    v_bfi_b32 v27, v62, s99, v27
    s_cbranch_scc0 L_far
    global_store_dwordx4 v52, v[24:27], s[42:43]
    s_mov_b64 exec, 0x101
    global_store_dwordx4 v54, v[40:43], s[42:43] offset:1024
L_pubd:
    s_cmp_lg_u32 s68, 0
    s_cbranch_scc1 L_h0end
    s_mov_b64 exec, -1
    s_mov_b32 s68, 1
    v_add_u32 v52, 294912, v52
    v_add_u32 v54, 294912, v54
    v_add_u32 v60, 4096, v60
    v_add_u32 v61, 2048, v61
    s_branch L_combb
L_far:
    global_store_dwordx4 v52, v[24:27], s[42:43] sc1
    s_mov_b64 exec, 0x101
    global_store_dwordx4 v54, v[40:43], s[42:43] offset:1024 sc1
    s_branch L_pubd
L_h0end:
    s_barrier
    s_endpgm
L_h1:
    v_mov_b32 v63, 1024
    v_mov_b32 v12, 0
    v_mov_b32 v13, 0
    ds_write_b64 v63, v[12:13]
    ds_write_b64 v63, v[12:13] offset:8
    ds_write_b64 v63, v[12:13] offset:16
    s_waitcnt lgkmcnt(0)
    s_barrier
    s_sub_u32 s69, s71, 128
    s_cmp_ge_u32 s69, 72
    s_cbranch_scc1 L_fin
    s_load_dwordx2 s[88:89], s[42:43], 0xf0000
    s_and_b32 s12, s69, 7
    s_mul_i32 s12, s12, 9
    s_lshr_b32 s69, s69, 3
    s_add_u32 s69, s69, s12
    v_mov_b32 v62, 0x3ff
    s_cmp_ge_u32 s69, 36
    s_cselect_b32 s12, 1152, 0
    s_cselect_b32 s13, 36, 0
    s_cselect_b32 s14, 576, 0
    s_sub_u32 s13, s69, s13
    s_mul_i32 s15, s13, 57
    s_lshr_b32 s15, s15, 9
    s_mul_i32 s8, s15, 9
    s_sub_u32 s13, s13, s8
    s_lshl_b32 s13, s13, 6
    s_add_u32 s13, s13, s14
    s_mul_i32 s15, s15, 1152
    s_add_u32 s13, s13, s15
    s_add_u32 s13, s13, 1048576
    v_lshrrev_b32 v8, 2, v1
    v_mul_u32_u24 v8, 4608, v8
    v_and_b32 v9, 3, v1
    v_lshl_add_u32 v8, v9, 4, v8
    v_add_u32 v56, s13, v8
    v_add_u32 v57, 73728, v56
    v_add_u32 v58, 147456, v56
    v_add_u32 v59, 221184, v56
    v_lshl_add_u32 v9, v9, 2, v2
    s_lshl_b32 s13, s69, 5
    v_lshl_add_u32 v55, v9, 1, s13
    v_and_b32 v8, 31, v1
    v_mul_u32_u24 v8, 36, v8
    v_add_u32 v10, s12, v8
    s_waitcnt lgkmcnt(0)
    s_add_u32 s88, s88, 1
    s_mul_i32 s96, s88, 0x9E3779B1
    s_xor_b32 s96, s96, 0x5BD1E995
    s_lshr_b32 s99, s96, 30
    s_lshl_b32 s97, s89, 2
    s_or_b32 s99, s99, s97
    s_lshl_b32 s99, s99, 3
    s_xor_b32 s99, s99, s96
    s_bfe_u32 s97, s96, 0xa000a
    s_bfe_u32 s98, s96, 0xa0014
    s_and_b32 s96, s96, 0x3ff
    s_and_b32 s99, s99, 0x3ff
    s_mov_b32 s11, 2097152
L_lw_g:
    ds_read_b32 v13, v63 offset:0
    s_waitcnt lgkmcnt(0)
    v_cmp_gt_u32 vcc, 4, v13
    s_cbranch_vccz L_lwd_g
    s_sleep 16
    s_sub_u32 s11, s11, 1
    s_cmp_lg_u32 s11, 0
    s_cbranch_scc1 L_lw_g
L_lwd_g:
    global_load_dwordx4 v[16:19], v10, s[16:17]
    global_load_dwordx4 v[20:23], v10, s[16:17] offset:16
    global_load_dword v24, v10, s[16:17] offset:32
    global_load_dwordx4 v[28:31], v8, s[36:37]
    global_load_dwordx4 v[32:35], v8, s[36:37] offset:16
    global_load_dword v36, v8, s[36:37] offset:32
    v_mov_b32 v40, 0
    v_mov_b32 v41, 0
    s_waitcnt vmcnt(0)
    v_lshlrev_b32 v42, 16, v16
    v_and_b32 v43, 0xffff0000, v16
    v_lshlrev_b32 v44, 16, v28
    v_and_b32 v45, 0xffff0000, v28
    v_mul_f32 v42, v42, v44
    v_mul_f32 v43, v43, v45
    v_cvt_pk_bf16_f32 v42, v42, v43
    v_and_b32 v43, 0xffff0000, v42
    v_lshlrev_b32 v42, 16, v42
    v_add_f32 v41, v41, v43
    v_add_f32 v40, v40, v42
    v_lshlrev_b32 v42, 16, v17
    v_and_b32 v43, 0xffff0000, v17
    v_lshlrev_b32 v44, 16, v29
    v_and_b32 v45, 0xffff0000, v29
    v_mul_f32 v42, v42, v44
    v_mul_f32 v43, v43, v45
    v_cvt_pk_bf16_f32 v42, v42, v43
    v_and_b32 v43, 0xffff0000, v42
    v_lshlrev_b32 v42, 16, v42
    v_add_f32 v41, v41, v43
    v_add_f32 v40, v40, v42
    v_lshlrev_b32 v42, 16, v18
    v_and_b32 v43, 0xffff0000, v18
    v_lshlrev_b32 v44, 16, v30
    v_and_b32 v45, 0xffff0000, v30
    v_mul_f32 v42, v42, v44
    v_mul_f32 v43, v43, v45
    v_cvt_pk_bf16_f32 v42, v42, v43
    v_and_b32 v43, 0xffff0000, v42
    v_lshlrev_b32 v42, 16, v42
    v_add_f32 v41, v41, v43
    v_add_f32 v40, v40, v42
    v_lshlrev_b32 v42, 16, v19
    v_and_b32 v43, 0xffff0000, v19
    v_lshlrev_b32 v44, 16, v31
    v_and_b32 v45, 0xffff0000, v31
    v_mul_f32 v42, v42, v44
    v_mul_f32 v43, v43, v45
    v_cvt_pk_bf16_f32 v42, v42, v43
    v_and_b32 v43, 0xffff0000, v42
    v_lshlrev_b32 v42, 16, v42
    v_add_f32 v41, v41, v43
    v_add_f32 v40, v40, v42
    v_lshlrev_b32 v42, 16, v20
    v_and_b32 v43, 0xffff0000, v20
    v_lshlrev_b32 v44, 16, v32
    v_and_b32 v45, 0xffff0000, v32
    v_mul_f32 v42, v42, v44
    v_mul_f32 v43, v43, v45
    v_cvt_pk_bf16_f32 v42, v42, v43
    v_and_b32 v43, 0xffff0000, v42
    v_lshlrev_b32 v42, 16, v42
    v_add_f32 v41, v41, v43
    v_add_f32 v40, v40, v42
    v_lshlrev_b32 v42, 16, v21
    v_and_b32 v43, 0xffff0000, v21
    v_lshlrev_b32 v44, 16, v33
    v_and_b32 v45, 0xffff0000, v33
    v_mul_f32 v42, v42, v44
    v_mul_f32 v43, v43, v45
    v_cvt_pk_bf16_f32 v42, v42, v43
    v_and_b32 v43, 0xffff0000, v42
    v_lshlrev_b32 v42, 16, v42
    v_add_f32 v41, v41, v43
    v_add_f32 v40, v40, v42
    v_lshlrev_b32 v42, 16, v22
    v_and_b32 v43, 0xffff0000, v22
    v_lshlrev_b32 v44, 16, v34
    v_and_b32 v45, 0xffff0000, v34
    v_mul_f32 v42, v42, v44
    v_mul_f32 v43, v43, v45
    v_cvt_pk_bf16_f32 v42, v42, v43
    v_and_b32 v43, 0xffff0000, v42
    v_lshlrev_b32 v42, 16, v42
    v_add_f32 v41, v41, v43
    v_add_f32 v40, v40, v42
    v_lshlrev_b32 v42, 16, v23
    v_and_b32 v43, 0xffff0000, v23
    v_lshlrev_b32 v44, 16, v35
    v_and_b32 v45, 0xffff0000, v35
    v_mul_f32 v42, v42, v44
    v_mul_f32 v43, v43, v45
    v_cvt_pk_bf16_f32 v42, v42, v43
    v_and_b32 v43, 0xffff0000, v42
    v_lshlrev_b32 v42, 16, v42
    v_add_f32 v41, v41, v43
    v_add_f32 v40, v40, v42
    v_lshlrev_b32 v42, 16, v24
    v_and_b32 v43, 0xffff0000, v24
    v_lshlrev_b32 v44, 16, v36
    v_and_b32 v45, 0xffff0000, v36
    v_mul_f32 v42, v42, v44
    v_mul_f32 v43, v43, v45
    v_cvt_pk_bf16_f32 v42, v42, v43
    v_and_b32 v43, 0xffff0000, v42
    v_lshlrev_b32 v42, 16, v42
    v_add_f32 v41, v41, v43
    v_add_f32 v40, v40, v42
    v_add_f32 v40, v40, v41
    s_nop 1
    v_add_f32_dpp v40, v40, v40 quad_perm:[1,0,3,2] row_mask:0xf bank_mask:0xf
    s_nop 1
    v_add_f32_dpp v40, v40, v40 quad_perm:[2,3,0,1] row_mask:0xf bank_mask:0xf
    s_nop 1
    v_add_f32_dpp v40, v40, v40 row_half_mirror row_mask:0xf bank_mask:0xf
    s_nop 1
    v_add_f32_dpp v40, v40, v40 row_mirror row_mask:0xf bank_mask:0xf
    s_nop 0
    v_mov_b32 v41, v40
    s_nop 1
    v_permlane16_swap_b32 v41, v40
    v_add_f32 v40, v40, v41
    v_cvt_pk_bf16_f32 v40, v40, v40
    v_lshlrev_b32 v40, 16, v40
    v_mul_f32 v40, 0xbfb8aa3b, v40
    v_exp_f32 v40, v40
    s_nop 0
    v_add_f32 v40, 1.0, v40
    v_rcp_f32 v40, v40
    s_nop 0
    v_cvt_pk_bf16_f32 v40, v40, v40
    v_lshlrev_b32 v50, 16, v40
    v_sub_f32 v41, 1.0, v50
    v_cvt_pk_bf16_f32 v41, v41, v41
    v_lshlrev_b32 v51, 16, v41
    s_barrier
    s_barrier
    s_mov_b32 s11, 2097152
L_lw_p:
    ds_read_b32 v13, v63 offset:16
    s_waitcnt lgkmcnt(0)
    v_cmp_gt_u32 vcc, 1, v13
    s_cbranch_vccz L_lwd_p
    s_sleep 1
    s_sub_u32 s11, s11, 1
    s_cmp_lg_u32 s11, 0
    s_cbranch_scc1 L_lw_p
L_lwd_p:
    s_mov_b32 s11, 262144
    s_mov_b64 s[90:91], -1
    global_load_dwordx4 v[64:67], v56, s[42:43] sc1
    global_load_dwordx4 v[68:71], v57, s[42:43] sc1
    global_load_dwordx4 v[72:75], v58, s[42:43] sc1
    global_load_dwordx4 v[76:79], v59, s[42:43] sc1
    s_sleep 6
    s_mov_b64 s[92:93], -1
    global_load_dwordx4 v[80:83], v56, s[42:43] sc1
    global_load_dwordx4 v[84:87], v57, s[42:43] sc1
    global_load_dwordx4 v[88:91], v58, s[42:43] sc1
    global_load_dwordx4 v[92:95], v59, s[42:43] sc1
L_p2_loop:
    s_mov_b64 exec, s[90:91]
    s_waitcnt vmcnt(7)
    v_xor_b32 v64, s96, v64
    v_xor_b32 v65, s97, v65
    v_xor_b32 v66, s98, v66
    v_xor_b32 v67, s99, v67
    v_or3_b32 v13, v64, v65, v66
    v_or_b32 v13, v13, v67
    s_waitcnt vmcnt(6)
    v_xor_b32 v68, s96, v68
    v_xor_b32 v69, s97, v69
    v_xor_b32 v70, s98, v70
    v_xor_b32 v71, s99, v71
    v_or3_b32 v13, v13, v68, v69
    v_or3_b32 v13, v13, v70, v71
    s_waitcnt vmcnt(5)
    v_xor_b32 v72, s96, v72
    v_xor_b32 v73, s97, v73
    v_xor_b32 v74, s98, v74
    v_xor_b32 v75, s99, v75
    v_or3_b32 v13, v13, v72, v73
    v_or3_b32 v13, v13, v74, v75
    s_waitcnt vmcnt(4)
    v_xor_b32 v76, s96, v76
    v_xor_b32 v77, s97, v77
    v_xor_b32 v78, s98, v78
    v_xor_b32 v79, s99, v79
    v_or3_b32 v13, v13, v76, v77
    v_or3_b32 v13, v13, v78, v79
    v_and_b32 v13, v13, v62
    v_cmp_ne_u32 vcc, 0, v13
    s_cbranch_vccz L_p2_d0
    s_mov_b64 exec, vcc
    s_mov_b64 s[90:91], vcc
    global_load_dwordx4 v[64:67], v56, s[42:43] sc1
    global_load_dwordx4 v[68:71], v57, s[42:43] sc1
    global_load_dwordx4 v[72:75], v58, s[42:43] sc1
    global_load_dwordx4 v[76:79], v59, s[42:43] sc1
    s_mov_b64 exec, s[92:93]
    s_waitcnt vmcnt(7)
    v_xor_b32 v80, s96, v80
    v_xor_b32 v81, s97, v81
    v_xor_b32 v82, s98, v82
    v_xor_b32 v83, s99, v83
    v_or3_b32 v13, v80, v81, v82
    v_or_b32 v13, v13, v83
    s_waitcnt vmcnt(6)
    v_xor_b32 v84, s96, v84
    v_xor_b32 v85, s97, v85
    v_xor_b32 v86, s98, v86
    v_xor_b32 v87, s99, v87
    v_or3_b32 v13, v13, v84, v85
    v_or3_b32 v13, v13, v86, v87
    s_waitcnt vmcnt(5)
    v_xor_b32 v88, s96, v88
    v_xor_b32 v89, s97, v89
    v_xor_b32 v90, s98, v90
    v_xor_b32 v91, s99, v91
    v_or3_b32 v13, v13, v88, v89
    v_or3_b32 v13, v13, v90, v91
    s_waitcnt vmcnt(4)
    v_xor_b32 v92, s96, v92
    v_xor_b32 v93, s97, v93
    v_xor_b32 v94, s98, v94
    v_xor_b32 v95, s99, v95
    v_or3_b32 v13, v13, v92, v93
    v_or3_b32 v13, v13, v94, v95
    v_and_b32 v13, v13, v62
    v_cmp_ne_u32 vcc, 0, v13
    s_cbranch_vccz L_p2_d1
    s_mov_b64 exec, vcc
    s_mov_b64 s[92:93], vcc
    global_load_dwordx4 v[80:83], v56, s[42:43] sc1
    global_load_dwordx4 v[84:87], v57, s[42:43] sc1
    global_load_dwordx4 v[88:91], v58, s[42:43] sc1
    global_load_dwordx4 v[92:95], v59, s[42:43] sc1
    s_sub_u32 s11, s11, 1
    s_cmp_lg_u32 s11, 0
    s_cbranch_scc1 L_p2_loop
L_p2_d1:
    s_mov_b64 exec, -1
    v_pk_add_f32 v[16:17], v[80:81], v[84:85]
    v_pk_add_f32 v[18:19], v[82:83], v[86:87]
    v_pk_add_f32 v[20:21], v[88:89], v[92:93]
    v_pk_add_f32 v[22:23], v[90:91], v[94:95]
    s_branch L_p2_go
L_p2_d0:
    s_mov_b64 exec, -1
    v_pk_add_f32 v[16:17], v[64:65], v[68:69]
    v_pk_add_f32 v[18:19], v[66:67], v[70:71]
    v_pk_add_f32 v[20:21], v[72:73], v[76:77]
    v_pk_add_f32 v[22:23], v[74:75], v[78:79]
L_p2_go:
    v_permlane32_swap_b32 v16, v18
    v_permlane32_swap_b32 v17, v19
    v_permlane32_swap_b32 v20, v22
    v_permlane32_swap_b32 v21, v23
    v_pk_add_f32 v[16:17], v[16:17], v[18:19]
    v_pk_add_f32 v[20:21], v[20:21], v[22:23]
    s_mov_b32 s12, 0x000f000f
    v_permlane16_swap_b32 v16, v17
    v_permlane16_swap_b32 v20, v21
    v_add_f32 v16, v16, v17
    v_add_f32 v20, v20, v21
    s_mov_b32 s13, 0x000f000f
    v_add_f32_dpp v16, v16, v16 row_ror:4 row_mask:0xf bank_mask:0xf
    v_add_f32_dpp v20, v20, v20 row_ror:4 row_mask:0xf bank_mask:0xf
    s_nop 0
    v_add_f32_dpp v16, v16, v16 row_ror:8 row_mask:0xf bank_mask:0xf
    v_add_f32_dpp v20, v20, v20 row_ror:8 row_mask:0xf bank_mask:0xf
    s_mov_b64 exec, s[12:13]
    v_cvt_pk_bf16_f32 v18, v16, v20
    v_and_b32 v19, 0xffff0000, v18
    v_lshlrev_b32 v18, 16, v18
    v_pk_mul_f32 v[18:19], v[18:19], v[50:51]
    v_cvt_pk_bf16_f32 v18, v18, v19
    v_and_b32 v20, 0xffff0000, v18
    v_lshlrev_b32 v18, 16, v18
    v_add_f32 v18, v18, v20
    v_cvt_pk_bf16_f32 v18, v18, v18
    global_store_short v55, v18, s[38:39]
    s_cmp_lg_u32 s69, 0
    s_cbranch_scc1 L_noep
    v_mov_b32 v17, 0xf0000
    v_mov_b32 v19, s88
    s_mov_b64 exec, 1
    global_store_dword v17, v19, s[42:43]
L_noep:
    s_endpgm
L_stream2:
    s_load_dwordx2 s[88:89], s[42:43], 0xf0000
    s_mov_b64 s[54:55], s[46:47]
    s_mov_b64 s[58:59], s[46:47]
    s_mov_b32 s66, 0x480000
    s_mov_b32 s67, 0x20000
    s_cmp_eq_u32 s4, 0
    s_cselect_b64 s[64:65], s[24:25], s[34:35]
    s_mov_b64 s[52:53], s[28:29]
    s_mov_b64 s[56:57], s[30:31]
    v_and_b32 v13, 1, v1
    v_lshlrev_b32 v13, 4, v13
    v_mov_b32 v14, 0xffff
    v_lshlrev_b32 v13, v13, v14
    v_bfe_u32 v14, v1, 1, 2
    v_cmp_eq_u32 vcc, 0, v14
    v_cmp_eq_u32 s[100:101], 1, v14
    v_mov_b32 v62, 0x3ff
    v_cndmask_b32 v4, 0, v13, vcc
    v_cndmask_b32 v5, 0, v13, s[100:101]
    v_cmp_eq_u32 vcc, 2, v14
    v_cmp_eq_u32 s[100:101], 3, v14
    v_lshlrev_b32 v60, 4, v1
    v_cndmask_b32 v6, 0, v13, vcc
    v_cndmask_b32 v7, 0, v13, s[100:101]
    v_mov_b32 v63, 1024
    v_lshrrev_b32 v55, 3, v3
    v_lshlrev_b32 v55, 8, v55
    v_lshl_add_u32 v55, v2, 6, v55
    v_lshl_add_u32 v55, v9, 4, v55
    s_lshl_b32 s13, s15, 10
    v_add_u32 v56, s13, v60
    s_lshl_b32 s13, s15, 9
    v_lshl_add_u32 v57, v1, 3, s13
    v_mov_b32 v59, 1
    s_mov_b32 s14, 0
    s_lshl_b32 s95, s7, 2
    s_add_u32 s95, s95, 0
    s_mul_i32 s95, s95, 4352
    s_add_u32 s95, s95, 1572864
    s_mov_b32 s8, 0xffff0000
    s_mov_b32 s9, 0x3db504f3
    s_mov_b32 s10, 0x3fb8aa3b
    v_mov_b32 v10, 0xff7f0000
    v_mov_b32 v11, 0
    v_mov_b32 v20, 0
    v_mov_b32 v21, 0
    v_mov_b32 v22, 0
    v_mov_b32 v23, 0
    s_lshr_b32 s92, s6, 2
    s_and_b32 s94, s6, 3
    v_and_b32 v53, 1, v2
    v_lshlrev_b32 v53, 2, v53
    v_lshrrev_b32 v54, 1, v2
    v_add_u32 v53, v53, v54
    v_mul_u32_u24 v48, 4608, v53
    v_lshl_add_u32 v48, v3, 4, v48
    s_lshl_b32 s12, s5, 8
    s_lshl_b32 s13, s92, 7
    s_add_u32 s12, s12, s13
    s_lshl_b32 s13, s15, 5
    s_add_u32 s12, s12, s13
    s_mul_i32 s70, s12, 1152
    s_mul_i32 s12, s94, 288
    s_add_u32 s70, s70, s12
    v_bfe_u32 v53, v1, 2, 3
    v_mul_u32_u24 v53, 1152, v53
    s_lshl_b32 s12, s4, 8
    s_lshl_b32 s13, s5, 3
    s_add_u32 s12, s12, s13
    s_mul_i32 s12, s12, 1152
    s_add_u32 s12, s12, 262144
    s_lshl_b32 s13, s92, 4
    s_add_u32 s13, s13, s12
    v_mul_u32_u24 v50, 147456, v54
    v_add3_u32 v50, v50, v53, s13
    s_lshl_b32 s13, s15, 8
    s_add_u32 s12, s12, s13
    s_lshl_b32 s13, s92, 7
    s_add_u32 s12, s12, s13
    v_lshl_add_u32 v53, v54, 6, v53
    v_and_b32 v54, 3, v1
    v_lshl_add_u32 v53, v54, 4, v53
    v_add_u32 v49, s12, v53
    v_add_u32 v0, 147456, v49
    s_mul_i32 s12, s2, 1152
    s_add_u32 s12, s12, 1048576
    v_add_u32 v51, s12, v60
    s_lshl_b32 s12, s94, 2
    s_lshr_b32 s12, 0xac68, s12
    s_and_b32 s94, s12, 15
    s_sub_u32 s92, 18, s94
    v_cmp_le_u32 vcc, 36, v1
    v_subrev_u32 v53, 36, v1
    v_mov_b32 v61, 0x200
    v_cndmask_b32 v53, v1, v53, vcc
    v_cndmask_b32 v61, 0, v61, vcc
    v_and_b32 v54, 1, v53
    v_lshl_add_u32 v61, v54, 8, v61
    v_lshrrev_b32 v53, 1, v53
    v_lshl_add_u32 v61, v53, 4, v61
    v_cmp_le_u32 vcc, s94, v53
    s_lshl_b32 s12, s94, 4
    s_sub_u32 s13, 0x400, s12
    v_add_u32 v53, s13, v61
    v_cndmask_b32 v61, v61, v53, vcc
    v_and_b32 v53, 1, v1
    v_lshlrev_b32 v53, 8, v53
    v_bfe_u32 v54, v1, 1, 2
    v_lshl_add_u32 v53, v54, 4, v53
    s_add_u32 s13, s13, 736
    v_add_u32 v53, s13, v53
    v_add_u32 v54, s12, v48
    v_bfrev_b32 v13, 1
    v_cmp_gt_u32 vcc, s94, v3
    v_cmp_gt_u32 s[100:101], s92, v3
    s_lshl_b32 s12, s15, 11
    v_cndmask_b32 v48, v13, v48, vcc
    v_cndmask_b32 v54, v13, v54, s[100:101]
    v_add_u32 v52, s12, v60
    s_barrier
    s_waitcnt vmcnt(4)
    buffer_load_dwordx4 v[148:151], v60, s[48:51], s93 offen offset:1024 nt
    s_waitcnt vmcnt(4)
    buffer_load_dwordx4 v[152:155], v60, s[48:51], s93 offen offset:2048 nt
    s_waitcnt vmcnt(4)
    buffer_load_dwordx4 v[156:159], v60, s[48:51], s93 offen offset:3072 nt
    s_add_u32 s68, s68, 131072
    s_xor_b32 s93, s68, s90
    s_waitcnt vmcnt(4)
    buffer_load_dwordx4 v[160:163], v8, s[44:47], s93 offen offset:0 nt
    s_waitcnt vmcnt(4)
    buffer_load_dwordx4 v[164:167], v8, s[44:47], s93 offen offset:1024 nt
    s_waitcnt vmcnt(4)
    buffer_load_dwordx4 v[168:171], v8, s[44:47], s93 offen offset:2048 nt
    s_waitcnt vmcnt(4)
    buffer_load_dwordx4 v[172:175], v8, s[44:47], s93 offen offset:3072 nt
    s_waitcnt vmcnt(4)
    buffer_load_dwordx4 v[176:179], v60, s[48:51], s93 offen offset:0 nt
    s_waitcnt vmcnt(4)
    buffer_load_dwordx4 v[180:183], v60, s[48:51], s93 offen offset:1024 nt
    s_waitcnt vmcnt(4)
    buffer_load_dwordx4 v[184:187], v60, s[48:51], s93 offen offset:2048 nt
    s_waitcnt vmcnt(4)
    buffer_load_dwordx4 v[188:191], v60, s[48:51], s93 offen offset:3072 nt
    s_waitcnt lgkmcnt(0)
    s_add_u32 s88, s88, 1
    s_mul_i32 s96, s88, 0x9E3779B1
    s_xor_b32 s96, s96, 0x5BD1E995
    s_lshr_b32 s99, s96, 30
    s_lshl_b32 s97, s89, 2
    s_or_b32 s99, s99, s97
    s_lshl_b32 s99, s99, 3
    s_xor_b32 s99, s99, s96
    s_bfe_u32 s97, s96, 0xa000a
    s_bfe_u32 s98, s96, 0xa0014
    s_and_b32 s96, s96, 0x3ff
    s_and_b32 s99, s99, 0x3ff
    s_add_u32 s68, s68, 131072
    s_xor_b32 s93, s68, s90
    s_waitcnt vmcnt(4)
    buffer_load_dwordx4 v[192:195], v8, s[44:47], s93 offen offset:0 nt
    s_waitcnt vmcnt(4)
    buffer_load_dwordx4 v[196:199], v8, s[44:47], s93 offen offset:1024 nt
    s_waitcnt vmcnt(4)
    buffer_load_dwordx4 v[200:203], v8, s[44:47], s93 offen offset:2048 nt
    s_waitcnt vmcnt(4)
    buffer_load_dwordx4 v[204:207], v8, s[44:47], s93 offen offset:3072 nt
    s_waitcnt vmcnt(4)
    buffer_load_dwordx4 v[208:211], v60, s[48:51], s93 offen offset:0 nt
    s_waitcnt vmcnt(4)
    buffer_load_dwordx4 v[212:215], v60, s[48:51], s93 offen offset:1024 nt
    s_waitcnt vmcnt(4)
    buffer_load_dwordx4 v[216:219], v60, s[48:51], s93 offen offset:2048 nt
    s_waitcnt vmcnt(4)
    buffer_load_dwordx4 v[220:223], v60, s[48:51], s93 offen offset:3072 nt
    s_add_u32 s68, s68, 131072
    s_xor_b32 s93, s68, s90
    s_waitcnt vmcnt(4)
    buffer_load_dwordx4 v[224:227], v8, s[44:47], s93 offen offset:0 nt
    s_waitcnt vmcnt(4)
    buffer_load_dwordx4 v[228:231], v8, s[44:47], s93 offen offset:1024 nt
    s_waitcnt vmcnt(4)
    buffer_load_dwordx4 v[232:235], v8, s[44:47], s93 offen offset:2048 nt
    s_waitcnt vmcnt(4)
    buffer_load_dwordx4 v[236:239], v8, s[44:47], s93 offen offset:3072 nt
    s_waitcnt vmcnt(4)
    buffer_load_dwordx4 v[240:243], v60, s[48:51], s93 offen offset:0 nt
    s_waitcnt vmcnt(4)
    buffer_load_dwordx4 v[244:247], v60, s[48:51], s93 offen offset:1024 nt
    s_waitcnt vmcnt(4)
    buffer_load_dwordx4 v[248:251], v60, s[48:51], s93 offen offset:2048 nt
    s_waitcnt vmcnt(4)
    buffer_load_dwordx4 v[252:255], v60, s[48:51], s93 offen offset:3072 nt
    s_sub_u32 s68, s68, 393216
    s_xor_b32 s93, s68, s91
    s_waitcnt vmcnt(4)
    buffer_load_dwordx4 v[96:99], v8, s[52:55], s93 offen offset:0 nt
    s_waitcnt vmcnt(4)
    buffer_load_dwordx4 v[100:103], v8, s[52:55], s93 offen offset:1024 nt
    s_waitcnt vmcnt(4)
    buffer_load_dwordx4 v[104:107], v8, s[52:55], s93 offen offset:2048 nt
    s_waitcnt vmcnt(4)
    buffer_load_dwordx4 v[108:111], v8, s[52:55], s93 offen offset:3072 nt
    s_waitcnt vmcnt(4)
    buffer_load_dwordx4 v[112:115], v60, s[56:59], s93 offen offset:0 nt
    s_waitcnt vmcnt(4)
    buffer_load_dwordx4 v[116:119], v60, s[56:59], s93 offen offset:1024 nt
    s_waitcnt vmcnt(4)
    buffer_load_dwordx4 v[120:123], v60, s[56:59], s93 offen offset:2048 nt
    s_waitcnt vmcnt(4)
    buffer_load_dwordx4 v[124:127], v60, s[56:59], s93 offen offset:3072 nt
    s_mov_b32 s11, 2097152
L_lw_q:
    ds_read_b32 v13, v63 offset:4
    s_waitcnt lgkmcnt(0)
    v_cmp_gt_u32 vcc, 1, v13
    s_cbranch_vccz L_lwd_q
    s_sleep 1
    s_sub_u32 s11, s11, 1
    s_cmp_lg_u32 s11, 0
    s_cbranch_scc1 L_lw_q
L_lwd_q:
    ds_read_b128 v[32:35], v55 offset:0
    s_waitcnt lgkmcnt(0)
    s_waitcnt vmcnt(39)
    v_mfma_f32_16x16x32_bf16 v[36:39], v[128:131], v[32:35], 0
    s_add_u32 s68, s68, 131072
    s_xor_b32 s93, s68, s91
    s_waitcnt vmcnt(4)
    buffer_load_dwordx4 v[128:131], v8, s[52:55], s93 offen offset:0 nt
    s_waitcnt vmcnt(39)
    v_mfma_f32_16x16x32_bf16 v[40:43], v[132:135], v[32:35], 0
    s_waitcnt vmcnt(4)
    buffer_load_dwordx4 v[132:135], v8, s[52:55], s93 offen offset:1024 nt
    s_nop 5
    v_mov_b32_dpp v16, v36 quad_perm:[0,0,0,0] row_mask:0xf bank_mask:0xf
    v_mov_b32_dpp v15, v38 quad_perm:[2,2,2,2] row_mask:0xf bank_mask:0xf
    s_nop 0
    v_add_f32_dpp v16, v37, v16 quad_perm:[1,1,1,1] row_mask:0xf bank_mask:0xf
    v_add_f32_dpp v15, v39, v15 quad_perm:[3,3,3,3] row_mask:0xf bank_mask:0xf
    v_add_f32 v16, v16, v15
    s_waitcnt vmcnt(39)
    v_mfma_f32_16x16x32_bf16 v[44:47], v[136:139], v[32:35], 0
    s_waitcnt vmcnt(4)
    buffer_load_dwordx4 v[136:139], v8, s[52:55], s93 offen offset:2048 nt
    v_mov_b32_dpp v17, v40 quad_perm:[0,0,0,0] row_mask:0xf bank_mask:0xf
    v_mov_b32_dpp v15, v42 quad_perm:[2,2,2,2] row_mask:0xf bank_mask:0xf
    s_nop 0
    v_add_f32_dpp v17, v41, v17 quad_perm:[1,1,1,1] row_mask:0xf bank_mask:0xf
    v_add_f32_dpp v15, v43, v15 quad_perm:[3,3,3,3] row_mask:0xf bank_mask:0xf
    v_add_f32 v17, v17, v15
    s_waitcnt vmcnt(39)
    v_mfma_f32_16x16x32_bf16 v[36:39], v[140:143], v[32:35], 0
    s_waitcnt vmcnt(4)
    buffer_load_dwordx4 v[140:143], v8, s[52:55], s93 offen offset:3072 nt
    v_mov_b32_dpp v18, v44 quad_perm:[0,0,0,0] row_mask:0xf bank_mask:0xf
    v_mov_b32_dpp v15, v46 quad_perm:[2,2,2,2] row_mask:0xf bank_mask:0xf
    s_nop 0
    v_add_f32_dpp v18, v45, v18 quad_perm:[1,1,1,1] row_mask:0xf bank_mask:0xf
    v_add_f32_dpp v15, v47, v15 quad_perm:[3,3,3,3] row_mask:0xf bank_mask:0xf
    v_add_f32 v18, v18, v15
    s_nop 1
    v_mov_b32_dpp v19, v36 quad_perm:[0,0,0,0] row_mask:0xf bank_mask:0xf
    v_mov_b32_dpp v15, v38 quad_perm:[2,2,2,2] row_mask:0xf bank_mask:0xf
    s_nop 0
    v_add_f32_dpp v19, v37, v19 quad_perm:[1,1,1,1] row_mask:0xf bank_mask:0xf
    v_add_f32_dpp v15, v39, v15 quad_perm:[3,3,3,3] row_mask:0xf bank_mask:0xf
    v_add_f32 v19, v19, v15
    v_cvt_pk_bf16_f32 v13, v16, v17
    v_cvt_pk_bf16_f32 v14, v18, v19
    v_lshlrev_b32 v16, 16, v13
    v_and_b32 v17, s8, v13
    v_lshlrev_b32 v18, 16, v14
    v_and_b32 v19, s8, v14
    v_mul_f32 v16, s9, v16
    v_mul_f32 v17, s9, v17
    v_mul_f32 v18, s9, v18
    v_mul_f32 v19, s9, v19
    v_cvt_pk_bf16_f32 v13, v16, v17
    v_cvt_pk_bf16_f32 v14, v18, v19
    v_lshlrev_b32 v16, 16, v13
    v_and_b32 v17, s8, v13
    v_lshlrev_b32 v18, 16, v14
    v_and_b32 v19, s8, v14
    v_max3_f32 v13, v16, v17, v18
    v_max3_f32 v13, v13, v19, v10
    v_mov_b32 v14, v13
    s_nop 1
    v_permlane32_swap_b32 v14, v13
    v_max_f32 v13, v13, v14
    v_mov_b32 v14, v13
    s_nop 1
    v_permlane16_swap_b32 v14, v13
    v_max_f32 v12, v13, v14
    v_sub_f32 v15, v10, v12
    v_pk_add_f32 v[16:17], v[16:17], v[12:13] op_sel_hi:[1,0] neg_lo:[0,1] neg_hi:[0,1]
    v_pk_add_f32 v[18:19], v[18:19], v[12:13] op_sel_hi:[1,0] neg_lo:[0,1] neg_hi:[0,1]
    v_mul_f32 v15, s10, v15
    v_pk_mul_f32 v[16:17], v[16:17], s[10:11] op_sel_hi:[1,0]
    v_pk_mul_f32 v[18:19], v[18:19], s[10:11] op_sel_hi:[1,0]
    v_exp_f32 v15, v15
    v_exp_f32 v16, v16
    v_exp_f32 v17, v17
    v_exp_f32 v18, v18
    v_exp_f32 v19, v19
    v_mov_b32 v10, v12
    v_mul_f32 v20, v20, v15
    v_mul_f32 v21, v21, v15
    v_mul_f32 v22, v22, v15
    v_mul_f32 v23, v23, v15
    v_fma_f32 v11, v11, v15, v16
    v_add_f32 v13, v17, v18
    v_add_f32 v11, v11, v19
    v_cvt_pk_bf16_f32 v16, v16, v16
    v_cvt_pk_bf16_f32 v17, v17, v17
    v_cvt_pk_bf16_f32 v18, v18, v18
    v_cvt_pk_bf16_f32 v19, v19, v19
    v_add_f32 v11, v11, v13
    v_and_b32 v24, v16, v4
    v_and_b32 v25, v16, v5
    v_and_b32 v26, v16, v6
    v_and_b32 v27, v16, v7
    v_and_b32 v28, v17, v4
    v_and_b32 v29, v17, v5
    v_and_b32 v30, v17, v6
    v_and_b32 v31, v17, v7
    v_and_b32 v36, v18, v4
    v_and_b32 v37, v18, v5
    v_and_b32 v38, v18, v6
    v_and_b32 v39, v18, v7
    v_and_b32 v40, v19, v4
    v_and_b32 v41, v19, v5
    v_and_b32 v42, v19, v6
    v_and_b32 v43, v19, v7
    s_waitcnt vmcnt(39)
    v_mfma_f32_16x16x32_bf16 v[20:23], v[144:147], v[24:27], v[20:23]
    s_waitcnt vmcnt(4)
    buffer_load_dwordx4 v[144:147], v60, s[56:59], s93 offen offset:0 nt
    s_waitcnt vmcnt(39)
    v_mfma_f32_16x16x32_bf16 v[20:23], v[148:151], v[28:31], v[20:23]
    s_waitcnt vmcnt(4)
    buffer_load_dwordx4 v[148:151], v60, s[56:59], s93 offen offset:1024 nt
    s_waitcnt vmcnt(39)
    v_mfma_f32_16x16x32_bf16 v[20:23], v[152:155], v[36:39], v[20:23]
    s_waitcnt vmcnt(4)
    buffer_load_dwordx4 v[152:155], v60, s[56:59], s93 offen offset:2048 nt
    s_waitcnt vmcnt(39)
    v_mfma_f32_16x16x32_bf16 v[20:23], v[156:159], v[40:43], v[20:23]
    s_waitcnt vmcnt(4)
    buffer_load_dwordx4 v[156:159], v60, s[56:59], s93 offen offset:3072 nt
    s_waitcnt vmcnt(39)
    v_mfma_f32_16x16x32_bf16 v[36:39], v[160:163], v[32:35], 0
    s_waitcnt vmcnt(38)
    v_mfma_f32_16x16x32_bf16 v[40:43], v[164:167], v[32:35], 0
    s_add_u32 s68, s68, 131072
    s_xor_b32 s93, s68, s91
    s_waitcnt vmcnt(4)
    buffer_load_dwordx4 v[160:163], v8, s[52:55], s93 offen offset:0 nt
    s_nop 5
    v_mov_b32_dpp v16, v36 quad_perm:[0,0,0,0] row_mask:0xf bank_mask:0xf
    v_mov_b32_dpp v15, v38 quad_perm:[2,2,2,2] row_mask:0xf bank_mask:0xf
    s_nop 0
    v_add_f32_dpp v16, v37, v16 quad_perm:[1,1,1,1] row_mask:0xf bank_mask:0xf
    v_add_f32_dpp v15, v39, v15 quad_perm:[3,3,3,3] row_mask:0xf bank_mask:0xf
    v_add_f32 v16, v16, v15
    s_waitcnt vmcnt(38)
    v_mfma_f32_16x16x32_bf16 v[44:47], v[168:171], v[32:35], 0
    v_mov_b32_dpp v17, v40 quad_perm:[0,0,0,0] row_mask:0xf bank_mask:0xf
    v_mov_b32_dpp v15, v42 quad_perm:[2,2,2,2] row_mask:0xf bank_mask:0xf
    s_nop 0
    v_add_f32_dpp v17, v41, v17 quad_perm:[1,1,1,1] row_mask:0xf bank_mask:0xf
    v_add_f32_dpp v15, v43, v15 quad_perm:[3,3,3,3] row_mask:0xf bank_mask:0xf
    v_add_f32 v17, v17, v15
    s_waitcnt vmcnt(37)
    v_mfma_f32_16x16x32_bf16 v[36:39], v[172:175], v[32:35], 0
    s_waitcnt vmcnt(4)
    buffer_load_dwordx4 v[164:167], v8, s[52:55], s93 offen offset:1024 nt
    v_mov_b32_dpp v18, v44 quad_perm:[0,0,0,0] row_mask:0xf bank_mask:0xf
    v_mov_b32_dpp v15, v46 quad_perm:[2,2,2,2] row_mask:0xf bank_mask:0xf
    s_nop 0
    v_add_f32_dpp v18, v45, v18 quad_perm:[1,1,1,1] row_mask:0xf bank_mask:0xf
    v_add_f32_dpp v15, v47, v15 quad_perm:[3,3,3,3] row_mask:0xf bank_mask:0xf
    v_add_f32 v18, v18, v15
    s_nop 1
    v_mov_b32_dpp v19, v36 quad_perm:[0,0,0,0] row_mask:0xf bank_mask:0xf
    v_mov_b32_dpp v15, v38 quad_perm:[2,2,2,2] row_mask:0xf bank_mask:0xf
    s_nop 0
    v_add_f32_dpp v19, v37, v19 quad_perm:[1,1,1,1] row_mask:0xf bank_mask:0xf
    v_add_f32_dpp v15, v39, v15 quad_perm:[3,3,3,3] row_mask:0xf bank_mask:0xf
    v_add_f32 v19, v19, v15
    v_cvt_pk_bf16_f32 v13, v16, v17
    v_cvt_pk_bf16_f32 v14, v18, v19
    v_lshlrev_b32 v16, 16, v13
    v_and_b32 v17, s8, v13
    v_lshlrev_b32 v18, 16, v14
    v_and_b32 v19, s8, v14
    v_mul_f32 v16, s9, v16
    v_mul_f32 v17, s9, v17
    v_mul_f32 v18, s9, v18
    v_mul_f32 v19, s9, v19
    v_cvt_pk_bf16_f32 v13, v16, v17
    v_cvt_pk_bf16_f32 v14, v18, v19
    v_lshlrev_b32 v16, 16, v13
    v_and_b32 v17, s8, v13
    v_lshlrev_b32 v18, 16, v14
    v_and_b32 v19, s8, v14
    v_max3_f32 v13, v16, v17, v18
    v_max3_f32 v13, v13, v19, v10
    v_mov_b32 v14, v13
    s_nop 1
    v_permlane32_swap_b32 v14, v13
    v_max_f32 v13, v13, v14
    v_mov_b32 v14, v13
    s_nop 1
    v_permlane16_swap_b32 v14, v13
    v_max_f32 v12, v13, v14
    v_sub_f32 v15, v10, v12
    v_pk_add_f32 v[16:17], v[16:17], v[12:13] op_sel_hi:[1,0] neg_lo:[0,1] neg_hi:[0,1]
    v_pk_add_f32 v[18:19], v[18:19], v[12:13] op_sel_hi:[1,0] neg_lo:[0,1] neg_hi:[0,1]
    v_mul_f32 v15, s10, v15
    v_pk_mul_f32 v[16:17], v[16:17], s[10:11] op_sel_hi:[1,0]
    v_pk_mul_f32 v[18:19], v[18:19], s[10:11] op_sel_hi:[1,0]
    v_exp_f32 v15, v15
    v_exp_f32 v16, v16
    v_exp_f32 v17, v17
    v_exp_f32 v18, v18
    v_exp_f32 v19, v19
    v_mov_b32 v10, v12
    v_mul_f32 v20, v20, v15
    v_mul_f32 v21, v21, v15
    v_mul_f32 v22, v22, v15
    v_mul_f32 v23, v23, v15
    v_fma_f32 v11, v11, v15, v16
    v_add_f32 v13, v17, v18
    v_add_f32 v11, v11, v19
    v_cvt_pk_bf16_f32 v16, v16, v16
    v_cvt_pk_bf16_f32 v17, v17, v17
    v_cvt_pk_bf16_f32 v18, v18, v18
    v_cvt_pk_bf16_f32 v19, v19, v19
    v_add_f32 v11, v11, v13
    v_and_b32 v24, v16, v4
    v_and_b32 v25, v16, v5
    v_and_b32 v26, v16, v6
    v_and_b32 v27, v16, v7
    v_and_b32 v28, v17, v4
    v_and_b32 v29, v17, v5
    v_and_b32 v30, v17, v6
    v_and_b32 v31, v17, v7
    v_and_b32 v36, v18, v4
    v_and_b32 v37, v18, v5
    v_and_b32 v38, v18, v6
    v_and_b32 v39, v18, v7
    v_and_b32 v40, v19, v4
    v_and_b32 v41, v19, v5
    v_and_b32 v42, v19, v6
    v_and_b32 v43, v19, v7
    s_waitcnt vmcnt(37)
    v_mfma_f32_16x16x32_bf16 v[20:23], v[176:179], v[24:27], v[20:23]
    s_waitcnt vmcnt(36)
    v_mfma_f32_16x16x32_bf16 v[20:23], v[180:183], v[28:31], v[20:23]
    s_waitcnt vmcnt(4)
    buffer_load_dwordx4 v[168:171], v8, s[52:55], s93 offen offset:2048 nt
    s_waitcnt vmcnt(36)
    v_mfma_f32_16x16x32_bf16 v[20:23], v[184:187], v[36:39], v[20:23]
    s_waitcnt vmcnt(35)
    v_mfma_f32_16x16x32_bf16 v[20:23], v[188:191], v[40:43], v[20:23]
    s_waitcnt vmcnt(4)
    buffer_load_dwordx4 v[172:175], v8, s[52:55], s93 offen offset:3072 nt
    s_waitcnt vmcnt(35)
    v_mfma_f32_16x16x32_bf16 v[36:39], v[192:195], v[32:35], 0
    s_waitcnt vmcnt(34)
    v_mfma_f32_16x16x32_bf16 v[40:43], v[196:199], v[32:35], 0
    s_waitcnt vmcnt(4)
    buffer_load_dwordx4 v[176:179], v60, s[56:59], s93 offen offset:0 nt
    s_nop 5
    v_mov_b32_dpp v16, v36 quad_perm:[0,0,0,0] row_mask:0xf bank_mask:0xf
    v_mov_b32_dpp v15, v38 quad_perm:[2,2,2,2] row_mask:0xf bank_mask:0xf
    s_nop 0
    v_add_f32_dpp v16, v37, v16 quad_perm:[1,1,1,1] row_mask:0xf bank_mask:0xf
    v_add_f32_dpp v15, v39, v15 quad_perm:[3,3,3,3] row_mask:0xf bank_mask:0xf
    v_add_f32 v16, v16, v15
    s_waitcnt vmcnt(34)
    v_mfma_f32_16x16x32_bf16 v[44:47], v[200:203], v[32:35], 0
    v_mov_b32_dpp v17, v40 quad_perm:[0,0,0,0] row_mask:0xf bank_mask:0xf
    v_mov_b32_dpp v15, v42 quad_perm:[2,2,2,2] row_mask:0xf bank_mask:0xf
    s_nop 0
    v_add_f32_dpp v17, v41, v17 quad_perm:[1,1,1,1] row_mask:0xf bank_mask:0xf
    v_add_f32_dpp v15, v43, v15 quad_perm:[3,3,3,3] row_mask:0xf bank_mask:0xf
    v_add_f32 v17, v17, v15
    s_waitcnt vmcnt(33)
    v_mfma_f32_16x16x32_bf16 v[36:39], v[204:207], v[32:35], 0
    s_waitcnt vmcnt(4)
    buffer_load_dwordx4 v[180:183], v60, s[56:59], s93 offen offset:1024 nt
    v_mov_b32_dpp v18, v44 quad_perm:[0,0,0,0] row_mask:0xf bank_mask:0xf
    v_mov_b32_dpp v15, v46 quad_perm:[2,2,2,2] row_mask:0xf bank_mask:0xf
    s_nop 0
    v_add_f32_dpp v18, v45, v18 quad_perm:[1,1,1,1] row_mask:0xf bank_mask:0xf
    v_add_f32_dpp v15, v47, v15 quad_perm:[3,3,3,3] row_mask:0xf bank_mask:0xf
    v_add_f32 v18, v18, v15
    s_nop 1
    v_mov_b32_dpp v19, v36 quad_perm:[0,0,0,0] row_mask:0xf bank_mask:0xf
    v_mov_b32_dpp v15, v38 quad_perm:[2,2,2,2] row_mask:0xf bank_mask:0xf
    s_nop 0
    v_add_f32_dpp v19, v37, v19 quad_perm:[1,1,1,1] row_mask:0xf bank_mask:0xf
    v_add_f32_dpp v15, v39, v15 quad_perm:[3,3,3,3] row_mask:0xf bank_mask:0xf
    v_add_f32 v19, v19, v15
    v_cvt_pk_bf16_f32 v13, v16, v17
    v_cvt_pk_bf16_f32 v14, v18, v19
    v_lshlrev_b32 v16, 16, v13
    v_and_b32 v17, s8, v13
    v_lshlrev_b32 v18, 16, v14
    v_and_b32 v19, s8, v14
    v_mul_f32 v16, s9, v16
    v_mul_f32 v17, s9, v17
    v_mul_f32 v18, s9, v18
    v_mul_f32 v19, s9, v19
    v_cvt_pk_bf16_f32 v13, v16, v17
    v_cvt_pk_bf16_f32 v14, v18, v19
    v_lshlrev_b32 v16, 16, v13
    v_and_b32 v17, s8, v13
    v_lshlrev_b32 v18, 16, v14
    v_and_b32 v19, s8, v14
    v_max3_f32 v13, v16, v17, v18
    v_max3_f32 v13, v13, v19, v10
    v_mov_b32 v14, v13
    s_nop 1
    v_permlane32_swap_b32 v14, v13
    v_max_f32 v13, v13, v14
    v_mov_b32 v14, v13
    s_nop 1
    v_permlane16_swap_b32 v14, v13
    v_max_f32 v12, v13, v14
    v_sub_f32 v15, v10, v12
    v_pk_add_f32 v[16:17], v[16:17], v[12:13] op_sel_hi:[1,0] neg_lo:[0,1] neg_hi:[0,1]
    v_pk_add_f32 v[18:19], v[18:19], v[12:13] op_sel_hi:[1,0] neg_lo:[0,1] neg_hi:[0,1]
    v_mul_f32 v15, s10, v15
    v_pk_mul_f32 v[16:17], v[16:17], s[10:11] op_sel_hi:[1,0]
    v_pk_mul_f32 v[18:19], v[18:19], s[10:11] op_sel_hi:[1,0]
    v_exp_f32 v15, v15
    v_exp_f32 v16, v16
    v_exp_f32 v17, v17
    v_exp_f32 v18, v18
    v_exp_f32 v19, v19
    v_mov_b32 v10, v12
    v_mul_f32 v20, v20, v15
    v_mul_f32 v21, v21, v15
    v_mul_f32 v22, v22, v15
    v_mul_f32 v23, v23, v15
    v_fma_f32 v11, v11, v15, v16
    v_add_f32 v13, v17, v18
    v_add_f32 v11, v11, v19
    v_cvt_pk_bf16_f32 v16, v16, v16
    v_cvt_pk_bf16_f32 v17, v17, v17
    v_cvt_pk_bf16_f32 v18, v18, v18
    v_cvt_pk_bf16_f32 v19, v19, v19
    v_add_f32 v11, v11, v13
    v_and_b32 v24, v16, v4
    v_and_b32 v25, v16, v5
    v_and_b32 v26, v16, v6
    v_and_b32 v27, v16, v7
    v_and_b32 v28, v17, v4
    v_and_b32 v29, v17, v5
    v_and_b32 v30, v17, v6
    v_and_b32 v31, v17, v7
    v_and_b32 v36, v18, v4
    v_and_b32 v37, v18, v5
    v_and_b32 v38, v18, v6
    v_and_b32 v39, v18, v7
    v_and_b32 v40, v19, v4
    v_and_b32 v41, v19, v5
    v_and_b32 v42, v19, v6
    v_and_b32 v43, v19, v7
    s_waitcnt vmcnt(33)
    v_mfma_f32_16x16x32_bf16 v[20:23], v[208:211], v[24:27], v[20:23]
    s_waitcnt vmcnt(32)
    v_mfma_f32_16x16x32_bf16 v[20:23], v[212:215], v[28:31], v[20:23]
    s_waitcnt vmcnt(4)
    buffer_load_dwordx4 v[184:187], v60, s[56:59], s93 offen offset:2048 nt
    s_waitcnt vmcnt(32)
    v_mfma_f32_16x16x32_bf16 v[20:23], v[216:219], v[36:39], v[20:23]
    s_waitcnt vmcnt(31)
    v_mfma_f32_16x16x32_bf16 v[20:23], v[220:223], v[40:43], v[20:23]
    s_waitcnt vmcnt(4)
    buffer_load_dwordx4 v[188:191], v60, s[56:59], s93 offen offset:3072 nt
    s_waitcnt vmcnt(31)
    v_mfma_f32_16x16x32_bf16 v[36:39], v[224:227], v[32:35], 0
    s_waitcnt vmcnt(30)
    v_mfma_f32_16x16x32_bf16 v[40:43], v[228:231], v[32:35], 0
    s_add_u32 s68, s68, 131072
    s_xor_b32 s93, s68, s91
    s_waitcnt vmcnt(4)
    buffer_load_dwordx4 v[192:195], v8, s[52:55], s93 offen offset:0 nt
    s_nop 5
    v_mov_b32_dpp v16, v36 quad_perm:[0,0,0,0] row_mask:0xf bank_mask:0xf
    v_mov_b32_dpp v15, v38 quad_perm:[2,2,2,2] row_mask:0xf bank_mask:0xf
    s_nop 0
    v_add_f32_dpp v16, v37, v16 quad_perm:[1,1,1,1] row_mask:0xf bank_mask:0xf
    v_add_f32_dpp v15, v39, v15 quad_perm:[3,3,3,3] row_mask:0xf bank_mask:0xf
    v_add_f32 v16, v16, v15
    s_waitcnt vmcnt(30)
    v_mfma_f32_16x16x32_bf16 v[44:47], v[232:235], v[32:35], 0
    v_mov_b32_dpp v17, v40 quad_perm:[0,0,0,0] row_mask:0xf bank_mask:0xf
    v_mov_b32_dpp v15, v42 quad_perm:[2,2,2,2] row_mask:0xf bank_mask:0xf
    s_nop 0
    v_add_f32_dpp v17, v41, v17 quad_perm:[1,1,1,1] row_mask:0xf bank_mask:0xf
    v_add_f32_dpp v15, v43, v15 quad_perm:[3,3,3,3] row_mask:0xf bank_mask:0xf
    v_add_f32 v17, v17, v15
    s_waitcnt vmcnt(29)
    v_mfma_f32_16x16x32_bf16 v[36:39], v[236:239], v[32:35], 0
    s_waitcnt vmcnt(4)
    buffer_load_dwordx4 v[196:199], v8, s[52:55], s93 offen offset:1024 nt
    ds_read_b128 v[32:35], v55 offset:512
    v_mov_b32_dpp v18, v44 quad_perm:[0,0,0,0] row_mask:0xf bank_mask:0xf
    v_mov_b32_dpp v15, v46 quad_perm:[2,2,2,2] row_mask:0xf bank_mask:0xf
    s_nop 0
    v_add_f32_dpp v18, v45, v18 quad_perm:[1,1,1,1] row_mask:0xf bank_mask:0xf
    v_add_f32_dpp v15, v47, v15 quad_perm:[3,3,3,3] row_mask:0xf bank_mask:0xf
    v_add_f32 v18, v18, v15
    s_nop 1
    v_mov_b32_dpp v19, v36 quad_perm:[0,0,0,0] row_mask:0xf bank_mask:0xf
    v_mov_b32_dpp v15, v38 quad_perm:[2,2,2,2] row_mask:0xf bank_mask:0xf
    s_nop 0
    v_add_f32_dpp v19, v37, v19 quad_perm:[1,1,1,1] row_mask:0xf bank_mask:0xf
    v_add_f32_dpp v15, v39, v15 quad_perm:[3,3,3,3] row_mask:0xf bank_mask:0xf
    v_add_f32 v19, v19, v15
    v_cvt_pk_bf16_f32 v13, v16, v17
    v_cvt_pk_bf16_f32 v14, v18, v19
    v_lshlrev_b32 v16, 16, v13
    v_and_b32 v17, s8, v13
    v_lshlrev_b32 v18, 16, v14
    v_and_b32 v19, s8, v14
    v_mul_f32 v16, s9, v16
    v_mul_f32 v17, s9, v17
    v_mul_f32 v18, s9, v18
    v_mul_f32 v19, s9, v19
    v_cvt_pk_bf16_f32 v13, v16, v17
    v_cvt_pk_bf16_f32 v14, v18, v19
    v_lshlrev_b32 v16, 16, v13
    v_and_b32 v17, s8, v13
    v_lshlrev_b32 v18, 16, v14
    v_and_b32 v19, s8, v14
    v_max3_f32 v13, v16, v17, v18
    v_max3_f32 v13, v13, v19, v10
    v_mov_b32 v14, v13
    s_nop 1
    v_permlane32_swap_b32 v14, v13
    v_max_f32 v13, v13, v14
    v_mov_b32 v14, v13
    s_nop 1
    v_permlane16_swap_b32 v14, v13
    v_max_f32 v12, v13, v14
    v_sub_f32 v15, v10, v12
    v_pk_add_f32 v[16:17], v[16:17], v[12:13] op_sel_hi:[1,0] neg_lo:[0,1] neg_hi:[0,1]
    v_pk_add_f32 v[18:19], v[18:19], v[12:13] op_sel_hi:[1,0] neg_lo:[0,1] neg_hi:[0,1]
    v_mul_f32 v15, s10, v15
    v_pk_mul_f32 v[16:17], v[16:17], s[10:11] op_sel_hi:[1,0]
    v_pk_mul_f32 v[18:19], v[18:19], s[10:11] op_sel_hi:[1,0]
    v_exp_f32 v15, v15
    v_exp_f32 v16, v16
    v_exp_f32 v17, v17
    v_exp_f32 v18, v18
    v_exp_f32 v19, v19
    v_mov_b32 v10, v12
    v_mul_f32 v20, v20, v15
    v_mul_f32 v21, v21, v15
    v_mul_f32 v22, v22, v15
    v_mul_f32 v23, v23, v15
    v_fma_f32 v11, v11, v15, v16
    v_add_f32 v13, v17, v18
    v_add_f32 v11, v11, v19
    v_cvt_pk_bf16_f32 v16, v16, v16
    v_cvt_pk_bf16_f32 v17, v17, v17
    v_cvt_pk_bf16_f32 v18, v18, v18
    v_cvt_pk_bf16_f32 v19, v19, v19
    v_add_f32 v11, v11, v13
    v_and_b32 v24, v16, v4
    v_and_b32 v25, v16, v5
    v_and_b32 v26, v16, v6
    v_and_b32 v27, v16, v7
    v_and_b32 v28, v17, v4
    v_and_b32 v29, v17, v5
    v_and_b32 v30, v17, v6
    v_and_b32 v31, v17, v7
    v_and_b32 v36, v18, v4
    v_and_b32 v37, v18, v5
    v_and_b32 v38, v18, v6
    v_and_b32 v39, v18, v7
    v_and_b32 v40, v19, v4
    v_and_b32 v41, v19, v5
    v_and_b32 v42, v19, v6
    v_and_b32 v43, v19, v7
    s_waitcnt vmcnt(29)
    v_mfma_f32_16x16x32_bf16 v[20:23], v[240:243], v[24:27], v[20:23]
    s_waitcnt vmcnt(28)
    v_mfma_f32_16x16x32_bf16 v[20:23], v[244:247], v[28:31], v[20:23]
    s_waitcnt vmcnt(4)
    buffer_load_dwordx4 v[200:203], v8, s[52:55], s93 offen offset:2048 nt
    s_waitcnt vmcnt(28)
    v_mfma_f32_16x16x32_bf16 v[20:23], v[248:251], v[36:39], v[20:23]
    s_waitcnt vmcnt(27)
    v_mfma_f32_16x16x32_bf16 v[20:23], v[252:255], v[40:43], v[20:23]
    s_waitcnt vmcnt(4)
    buffer_load_dwordx4 v[204:207], v8, s[52:55], s93 offen offset:3072 nt
    v_mov_b32 v14, v11
    s_nop 1
    v_permlane32_swap_b32 v14, v11
    v_add_f32 v11, v11, v14
    v_mov_b32 v14, v11
    s_nop 1
    v_permlane16_swap_b32 v14, v11
    v_add_f32 v11, v11, v14
    ds_write_b128 v56, v[20:23] offset:6144
    ds_write_b64 v57, v[10:11] offset:2048
    s_waitcnt lgkmcnt(0)
    s_mov_b64 exec, 1
    ds_add_u32 v63, v59
    s_mov_b64 exec, -1
    v_mov_b32 v10, 0xff7f0000
    v_mov_b32 v11, 0
    v_mov_b32 v20, 0
    v_mov_b32 v21, 0
    v_mov_b32 v22, 0
    v_mov_b32 v23, 0
    s_waitcnt vmcnt(27)
    v_mfma_f32_16x16x32_bf16 v[36:39], v[96:99], v[32:35], 0
    s_waitcnt vmcnt(26)
    v_mfma_f32_16x16x32_bf16 v[40:43], v[100:103], v[32:35], 0
    s_waitcnt vmcnt(4)
    buffer_load_dwordx4 v[208:211], v60, s[56:59], s93 offen offset:0 nt
    s_nop 5
    v_mov_b32_dpp v16, v36 quad_perm:[0,0,0,0] row_mask:0xf bank_mask:0xf
    v_mov_b32_dpp v15, v38 quad_perm:[2,2,2,2] row_mask:0xf bank_mask:0xf
    s_nop 0
    v_add_f32_dpp v16, v37, v16 quad_perm:[1,1,1,1] row_mask:0xf bank_mask:0xf
    v_add_f32_dpp v15, v39, v15 quad_perm:[3,3,3,3] row_mask:0xf bank_mask:0xf
    v_add_f32 v16, v16, v15
    s_waitcnt vmcnt(26)
    v_mfma_f32_16x16x32_bf16 v[44:47], v[104:107], v[32:35], 0
    v_mov_b32_dpp v17, v40 quad_perm:[0,0,0,0] row_mask:0xf bank_mask:0xf
    v_mov_b32_dpp v15, v42 quad_perm:[2,2,2,2] row_mask:0xf bank_mask:0xf
    s_nop 0
    v_add_f32_dpp v17, v41, v17 quad_perm:[1,1,1,1] row_mask:0xf bank_mask:0xf
    v_add_f32_dpp v15, v43, v15 quad_perm:[3,3,3,3] row_mask:0xf bank_mask:0xf
    v_add_f32 v17, v17, v15
    s_waitcnt vmcnt(25)
    v_mfma_f32_16x16x32_bf16 v[36:39], v[108:111], v[32:35], 0
    s_waitcnt vmcnt(4)
    buffer_load_dwordx4 v[212:215], v60, s[56:59], s93 offen offset:1024 nt
    v_mov_b32_dpp v18, v44 quad_perm:[0,0,0,0] row_mask:0xf bank_mask:0xf
    v_mov_b32_dpp v15, v46 quad_perm:[2,2,2,2] row_mask:0xf bank_mask:0xf
    s_nop 0
    v_add_f32_dpp v18, v45, v18 quad_perm:[1,1,1,1] row_mask:0xf bank_mask:0xf
    v_add_f32_dpp v15, v47, v15 quad_perm:[3,3,3,3] row_mask:0xf bank_mask:0xf
    v_add_f32 v18, v18, v15
    s_nop 1
    v_mov_b32_dpp v19, v36 quad_perm:[0,0,0,0] row_mask:0xf bank_mask:0xf
    v_mov_b32_dpp v15, v38 quad_perm:[2,2,2,2] row_mask:0xf bank_mask:0xf
    s_nop 0
    v_add_f32_dpp v19, v37, v19 quad_perm:[1,1,1,1] row_mask:0xf bank_mask:0xf
    v_add_f32_dpp v15, v39, v15 quad_perm:[3,3,3,3] row_mask:0xf bank_mask:0xf
    v_add_f32 v19, v19, v15
    v_cvt_pk_bf16_f32 v13, v16, v17
    v_cvt_pk_bf16_f32 v14, v18, v19
    v_lshlrev_b32 v16, 16, v13
    v_and_b32 v17, s8, v13
    v_lshlrev_b32 v18, 16, v14
    v_and_b32 v19, s8, v14
    v_mul_f32 v16, s9, v16
    v_mul_f32 v17, s9, v17
    v_mul_f32 v18, s9, v18
    v_mul_f32 v19, s9, v19
    v_cvt_pk_bf16_f32 v13, v16, v17
    v_cvt_pk_bf16_f32 v14, v18, v19
    v_lshlrev_b32 v16, 16, v13
    v_and_b32 v17, s8, v13
    v_lshlrev_b32 v18, 16, v14
    v_and_b32 v19, s8, v14
    v_max3_f32 v13, v16, v17, v18
    v_max3_f32 v13, v13, v19, v10
    v_mov_b32 v14, v13
    s_nop 1
    v_permlane32_swap_b32 v14, v13
    v_max_f32 v13, v13, v14
    v_mov_b32 v14, v13
    s_nop 1
    v_permlane16_swap_b32 v14, v13
    v_max_f32 v12, v13, v14
    v_sub_f32 v15, v10, v12
    v_pk_add_f32 v[16:17], v[16:17], v[12:13] op_sel_hi:[1,0] neg_lo:[0,1] neg_hi:[0,1]
    v_pk_add_f32 v[18:19], v[18:19], v[12:13] op_sel_hi:[1,0] neg_lo:[0,1] neg_hi:[0,1]
    v_mul_f32 v15, s10, v15
    v_pk_mul_f32 v[16:17], v[16:17], s[10:11] op_sel_hi:[1,0]
    v_pk_mul_f32 v[18:19], v[18:19], s[10:11] op_sel_hi:[1,0]
    v_exp_f32 v15, v15
    v_exp_f32 v16, v16
    v_exp_f32 v17, v17
    v_exp_f32 v18, v18
    v_exp_f32 v19, v19
    v_mov_b32 v10, v12
    v_mul_f32 v20, v20, v15
    v_mul_f32 v21, v21, v15
    v_mul_f32 v22, v22, v15
    v_mul_f32 v23, v23, v15
    v_fma_f32 v11, v11, v15, v16
    v_add_f32 v13, v17, v18
    v_add_f32 v11, v11, v19
    v_cvt_pk_bf16_f32 v16, v16, v16
    v_cvt_pk_bf16_f32 v17, v17, v17
    v_cvt_pk_bf16_f32 v18, v18, v18
    v_cvt_pk_bf16_f32 v19, v19, v19
    v_add_f32 v11, v11, v13
    v_and_b32 v24, v16, v4
    v_and_b32 v25, v16, v5
    v_and_b32 v26, v16, v6
    v_and_b32 v27, v16, v7
    v_and_b32 v28, v17, v4
    v_and_b32 v29, v17, v5
    v_and_b32 v30, v17, v6
    v_and_b32 v31, v17, v7
    v_and_b32 v36, v18, v4
    v_and_b32 v37, v18, v5
    v_and_b32 v38, v18, v6
    v_and_b32 v39, v18, v7
    v_and_b32 v40, v19, v4
    v_and_b32 v41, v19, v5
    v_and_b32 v42, v19, v6
    v_and_b32 v43, v19, v7
    s_waitcnt vmcnt(25)
    v_mfma_f32_16x16x32_bf16 v[20:23], v[112:115], v[24:27], v[20:23]
    s_waitcnt vmcnt(24)
    v_mfma_f32_16x16x32_bf16 v[20:23], v[116:119], v[28:31], v[20:23]
    s_waitcnt vmcnt(4)
    buffer_load_dwordx4 v[216:219], v60, s[56:59], s93 offen offset:2048 nt
    s_waitcnt vmcnt(24)
    v_mfma_f32_16x16x32_bf16 v[20:23], v[120:123], v[36:39], v[20:23]
    s_waitcnt vmcnt(23)
    v_mfma_f32_16x16x32_bf16 v[20:23], v[124:127], v[40:43], v[20:23]
    s_waitcnt vmcnt(4)
    buffer_load_dwordx4 v[220:223], v60, s[56:59], s93 offen offset:3072 nt
    s_waitcnt vmcnt(23)
    v_mfma_f32_16x16x32_bf16 v[36:39], v[128:131], v[32:35], 0
    s_waitcnt vmcnt(22)
    v_mfma_f32_16x16x32_bf16 v[40:43], v[132:135], v[32:35], 0
    s_add_u32 s68, s68, 131072
    s_xor_b32 s93, s68, s91
    s_waitcnt vmcnt(4)
    buffer_load_dwordx4 v[224:227], v8, s[52:55], s93 offen offset:0 nt
    s_nop 5
    v_mov_b32_dpp v16, v36 quad_perm:[0,0,0,0] row_mask:0xf bank_mask:0xf
    v_mov_b32_dpp v15, v38 quad_perm:[2,2,2,2] row_mask:0xf bank_mask:0xf
    s_nop 0
    v_add_f32_dpp v16, v37, v16 quad_perm:[1,1,1,1] row_mask:0xf bank_mask:0xf
    v_add_f32_dpp v15, v39, v15 quad_perm:[3,3,3,3] row_mask:0xf bank_mask:0xf
    v_add_f32 v16, v16, v15
    s_waitcnt vmcnt(22)
    v_mfma_f32_16x16x32_bf16 v[44:47], v[136:139], v[32:35], 0
    v_mov_b32_dpp v17, v40 quad_perm:[0,0,0,0] row_mask:0xf bank_mask:0xf
    v_mov_b32_dpp v15, v42 quad_perm:[2,2,2,2] row_mask:0xf bank_mask:0xf
    s_nop 0
    v_add_f32_dpp v17, v41, v17 quad_perm:[1,1,1,1] row_mask:0xf bank_mask:0xf
    v_add_f32_dpp v15, v43, v15 quad_perm:[3,3,3,3] row_mask:0xf bank_mask:0xf
    v_add_f32 v17, v17, v15
    s_waitcnt vmcnt(21)
    v_mfma_f32_16x16x32_bf16 v[36:39], v[140:143], v[32:35], 0
    s_waitcnt vmcnt(4)
    buffer_load_dwordx4 v[228:231], v8, s[52:55], s93 offen offset:1024 nt
    v_mov_b32_dpp v18, v44 quad_perm:[0,0,0,0] row_mask:0xf bank_mask:0xf
    v_mov_b32_dpp v15, v46 quad_perm:[2,2,2,2] row_mask:0xf bank_mask:0xf
    s_nop 0
    v_add_f32_dpp v18, v45, v18 quad_perm:[1,1,1,1] row_mask:0xf bank_mask:0xf
    v_add_f32_dpp v15, v47, v15 quad_perm:[3,3,3,3] row_mask:0xf bank_mask:0xf
    v_add_f32 v18, v18, v15
    s_nop 1
    v_mov_b32_dpp v19, v36 quad_perm:[0,0,0,0] row_mask:0xf bank_mask:0xf
    v_mov_b32_dpp v15, v38 quad_perm:[2,2,2,2] row_mask:0xf bank_mask:0xf
    s_nop 0
    v_add_f32_dpp v19, v37, v19 quad_perm:[1,1,1,1] row_mask:0xf bank_mask:0xf
    v_add_f32_dpp v15, v39, v15 quad_perm:[3,3,3,3] row_mask:0xf bank_mask:0xf
    v_add_f32 v19, v19, v15
    v_cvt_pk_bf16_f32 v13, v16, v17
    v_cvt_pk_bf16_f32 v14, v18, v19
    v_lshlrev_b32 v16, 16, v13
    v_and_b32 v17, s8, v13
    v_lshlrev_b32 v18, 16, v14
    v_and_b32 v19, s8, v14
    v_mul_f32 v16, s9, v16
    v_mul_f32 v17, s9, v17
    v_mul_f32 v18, s9, v18
    v_mul_f32 v19, s9, v19
    v_cvt_pk_bf16_f32 v13, v16, v17
    v_cvt_pk_bf16_f32 v14, v18, v19
    v_lshlrev_b32 v16, 16, v13
    v_and_b32 v17, s8, v13
    v_lshlrev_b32 v18, 16, v14
    v_and_b32 v19, s8, v14
    v_max3_f32 v13, v16, v17, v18
    v_max3_f32 v13, v13, v19, v10
    v_mov_b32 v14, v13
    s_nop 1
    v_permlane32_swap_b32 v14, v13
    v_max_f32 v13, v13, v14
    v_mov_b32 v14, v13
    s_nop 1
    v_permlane16_swap_b32 v14, v13
    v_max_f32 v12, v13, v14
    v_sub_f32 v15, v10, v12
    v_pk_add_f32 v[16:17], v[16:17], v[12:13] op_sel_hi:[1,0] neg_lo:[0,1] neg_hi:[0,1]
    v_pk_add_f32 v[18:19], v[18:19], v[12:13] op_sel_hi:[1,0] neg_lo:[0,1] neg_hi:[0,1]
    v_mul_f32 v15, s10, v15
    v_pk_mul_f32 v[16:17], v[16:17], s[10:11] op_sel_hi:[1,0]
    v_pk_mul_f32 v[18:19], v[18:19], s[10:11] op_sel_hi:[1,0]
    v_exp_f32 v15, v15
    v_exp_f32 v16, v16
    v_exp_f32 v17, v17
    v_exp_f32 v18, v18
    v_exp_f32 v19, v19
    v_mov_b32 v10, v12
    v_mul_f32 v20, v20, v15
    v_mul_f32 v21, v21, v15
    v_mul_f32 v22, v22, v15
    v_mul_f32 v23, v23, v15
    v_fma_f32 v11, v11, v15, v16
    v_add_f32 v13, v17, v18
    v_add_f32 v11, v11, v19
    v_cvt_pk_bf16_f32 v16, v16, v16
    v_cvt_pk_bf16_f32 v17, v17, v17
    v_cvt_pk_bf16_f32 v18, v18, v18
    v_cvt_pk_bf16_f32 v19, v19, v19
    v_add_f32 v11, v11, v13
    v_and_b32 v24, v16, v4
    v_and_b32 v25, v16, v5
    v_and_b32 v26, v16, v6
    v_and_b32 v27, v16, v7
    v_and_b32 v28, v17, v4
    v_and_b32 v29, v17, v5
    v_and_b32 v30, v17, v6
    v_and_b32 v31, v17, v7
    v_and_b32 v36, v18, v4
    v_and_b32 v37, v18, v5
    v_and_b32 v38, v18, v6
    v_and_b32 v39, v18, v7
    v_and_b32 v40, v19, v4
    v_and_b32 v41, v19, v5
    v_and_b32 v42, v19, v6
    v_and_b32 v43, v19, v7
    s_waitcnt vmcnt(21)
    v_mfma_f32_16x16x32_bf16 v[20:23], v[144:147], v[24:27], v[20:23]
    s_waitcnt vmcnt(20)
    v_mfma_f32_16x16x32_bf16 v[20:23], v[148:151], v[28:31], v[20:23]
    s_waitcnt vmcnt(4)
    buffer_load_dwordx4 v[232:235], v8, s[52:55], s93 offen offset:2048 nt
    s_waitcnt vmcnt(20)
    v_mfma_f32_16x16x32_bf16 v[20:23], v[152:155], v[36:39], v[20:23]
    s_waitcnt vmcnt(19)
    v_mfma_f32_16x16x32_bf16 v[20:23], v[156:159], v[40:43], v[20:23]
    s_waitcnt vmcnt(4)
    buffer_load_dwordx4 v[236:239], v8, s[52:55], s93 offen offset:3072 nt
    s_waitcnt vmcnt(19)
    v_mfma_f32_16x16x32_bf16 v[36:39], v[160:163], v[32:35], 0
    s_waitcnt vmcnt(18)
    v_mfma_f32_16x16x32_bf16 v[40:43], v[164:167], v[32:35], 0
    s_waitcnt vmcnt(4)
    buffer_load_dwordx4 v[240:243], v60, s[56:59], s93 offen offset:0 nt
    s_nop 5
    v_mov_b32_dpp v16, v36 quad_perm:[0,0,0,0] row_mask:0xf bank_mask:0xf
    v_mov_b32_dpp v15, v38 quad_perm:[2,2,2,2] row_mask:0xf bank_mask:0xf
    s_nop 0
    v_add_f32_dpp v16, v37, v16 quad_perm:[1,1,1,1] row_mask:0xf bank_mask:0xf
    v_add_f32_dpp v15, v39, v15 quad_perm:[3,3,3,3] row_mask:0xf bank_mask:0xf
    v_add_f32 v16, v16, v15
    s_waitcnt vmcnt(18)
    v_mfma_f32_16x16x32_bf16 v[44:47], v[168:171], v[32:35], 0
    v_mov_b32_dpp v17, v40 quad_perm:[0,0,0,0] row_mask:0xf bank_mask:0xf
    v_mov_b32_dpp v15, v42 quad_perm:[2,2,2,2] row_mask:0xf bank_mask:0xf
    s_nop 0
    v_add_f32_dpp v17, v41, v17 quad_perm:[1,1,1,1] row_mask:0xf bank_mask:0xf
    v_add_f32_dpp v15, v43, v15 quad_perm:[3,3,3,3] row_mask:0xf bank_mask:0xf
    v_add_f32 v17, v17, v15
    s_waitcnt vmcnt(17)
    v_mfma_f32_16x16x32_bf16 v[36:39], v[172:175], v[32:35], 0
    s_waitcnt vmcnt(4)
    buffer_load_dwordx4 v[244:247], v60, s[56:59], s93 offen offset:1024 nt
    v_mov_b32_dpp v18, v44 quad_perm:[0,0,0,0] row_mask:0xf bank_mask:0xf
    v_mov_b32_dpp v15, v46 quad_perm:[2,2,2,2] row_mask:0xf bank_mask:0xf
    s_nop 0
    v_add_f32_dpp v18, v45, v18 quad_perm:[1,1,1,1] row_mask:0xf bank_mask:0xf
    v_add_f32_dpp v15, v47, v15 quad_perm:[3,3,3,3] row_mask:0xf bank_mask:0xf
    v_add_f32 v18, v18, v15
    s_nop 1
    v_mov_b32_dpp v19, v36 quad_perm:[0,0,0,0] row_mask:0xf bank_mask:0xf
    v_mov_b32_dpp v15, v38 quad_perm:[2,2,2,2] row_mask:0xf bank_mask:0xf
    s_nop 0
    v_add_f32_dpp v19, v37, v19 quad_perm:[1,1,1,1] row_mask:0xf bank_mask:0xf
    v_add_f32_dpp v15, v39, v15 quad_perm:[3,3,3,3] row_mask:0xf bank_mask:0xf
    v_add_f32 v19, v19, v15
    v_cvt_pk_bf16_f32 v13, v16, v17
    v_cvt_pk_bf16_f32 v14, v18, v19
    v_lshlrev_b32 v16, 16, v13
    v_and_b32 v17, s8, v13
    v_lshlrev_b32 v18, 16, v14
    v_and_b32 v19, s8, v14
    v_mul_f32 v16, s9, v16
    v_mul_f32 v17, s9, v17
    v_mul_f32 v18, s9, v18
    v_mul_f32 v19, s9, v19
    v_cvt_pk_bf16_f32 v13, v16, v17
    v_cvt_pk_bf16_f32 v14, v18, v19
    v_lshlrev_b32 v16, 16, v13
    v_and_b32 v17, s8, v13
    v_lshlrev_b32 v18, 16, v14
    v_and_b32 v19, s8, v14
    v_max3_f32 v13, v16, v17, v18
    v_max3_f32 v13, v13, v19, v10
    v_mov_b32 v14, v13
    s_nop 1
    v_permlane32_swap_b32 v14, v13
    v_max_f32 v13, v13, v14
    v_mov_b32 v14, v13
    s_nop 1
    v_permlane16_swap_b32 v14, v13
    v_max_f32 v12, v13, v14
    v_sub_f32 v15, v10, v12
    v_pk_add_f32 v[16:17], v[16:17], v[12:13] op_sel_hi:[1,0] neg_lo:[0,1] neg_hi:[0,1]
    v_pk_add_f32 v[18:19], v[18:19], v[12:13] op_sel_hi:[1,0] neg_lo:[0,1] neg_hi:[0,1]
    v_mul_f32 v15, s10, v15
    v_pk_mul_f32 v[16:17], v[16:17], s[10:11] op_sel_hi:[1,0]
    v_pk_mul_f32 v[18:19], v[18:19], s[10:11] op_sel_hi:[1,0]
    v_exp_f32 v15, v15
    v_exp_f32 v16, v16
    v_exp_f32 v17, v17
    v_exp_f32 v18, v18
    v_exp_f32 v19, v19
    v_mov_b32 v10, v12
    v_mul_f32 v20, v20, v15
    v_mul_f32 v21, v21, v15
    v_mul_f32 v22, v22, v15
    v_mul_f32 v23, v23, v15
    v_fma_f32 v11, v11, v15, v16
    v_add_f32 v13, v17, v18
    v_add_f32 v11, v11, v19
    v_cvt_pk_bf16_f32 v16, v16, v16
    v_cvt_pk_bf16_f32 v17, v17, v17
    v_cvt_pk_bf16_f32 v18, v18, v18
    v_cvt_pk_bf16_f32 v19, v19, v19
    v_add_f32 v11, v11, v13
    v_and_b32 v24, v16, v4
    v_and_b32 v25, v16, v5
    v_and_b32 v26, v16, v6
    v_and_b32 v27, v16, v7
    v_and_b32 v28, v17, v4
    v_and_b32 v29, v17, v5
    v_and_b32 v30, v17, v6
    v_and_b32 v31, v17, v7
    v_and_b32 v36, v18, v4
    v_and_b32 v37, v18, v5
    v_and_b32 v38, v18, v6
    v_and_b32 v39, v18, v7
    v_and_b32 v40, v19, v4
    v_and_b32 v41, v19, v5
    v_and_b32 v42, v19, v6
    v_and_b32 v43, v19, v7
    s_waitcnt vmcnt(17)
    v_mfma_f32_16x16x32_bf16 v[20:23], v[176:179], v[24:27], v[20:23]
    s_waitcnt vmcnt(16)
    v_mfma_f32_16x16x32_bf16 v[20:23], v[180:183], v[28:31], v[20:23]
    s_waitcnt vmcnt(4)
    buffer_load_dwordx4 v[248:251], v60, s[56:59], s93 offen offset:2048 nt
    s_waitcnt vmcnt(16)
    v_mfma_f32_16x16x32_bf16 v[20:23], v[184:187], v[36:39], v[20:23]
    s_waitcnt vmcnt(15)
    v_mfma_f32_16x16x32_bf16 v[20:23], v[188:191], v[40:43], v[20:23]
    s_waitcnt vmcnt(4)
    buffer_load_dwordx4 v[252:255], v60, s[56:59], s93 offen offset:3072 nt
    s_waitcnt vmcnt(15)
    v_mfma_f32_16x16x32_bf16 v[36:39], v[192:195], v[32:35], 0
    s_waitcnt vmcnt(14)
    v_mfma_f32_16x16x32_bf16 v[40:43], v[196:199], v[32:35], 0
    s_add_u32 s68, s68, 131072
    s_xor_b32 s93, s68, s91
    s_waitcnt vmcnt(4)
    buffer_load_dwordx4 v[96:99], v8, s[52:55], s93 offen offset:0 nt
    s_nop 5
    v_mov_b32_dpp v16, v36 quad_perm:[0,0,0,0] row_mask:0xf bank_mask:0xf
    v_mov_b32_dpp v15, v38 quad_perm:[2,2,2,2] row_mask:0xf bank_mask:0xf
    s_nop 0
    v_add_f32_dpp v16, v37, v16 quad_perm:[1,1,1,1] row_mask:0xf bank_mask:0xf
    v_add_f32_dpp v15, v39, v15 quad_perm:[3,3,3,3] row_mask:0xf bank_mask:0xf
    v_add_f32 v16, v16, v15
    s_waitcnt vmcnt(14)
    v_mfma_f32_16x16x32_bf16 v[44:47], v[200:203], v[32:35], 0
    v_mov_b32_dpp v17, v40 quad_perm:[0,0,0,0] row_mask:0xf bank_mask:0xf
    v_mov_b32_dpp v15, v42 quad_perm:[2,2,2,2] row_mask:0xf bank_mask:0xf
    s_nop 0
    v_add_f32_dpp v17, v41, v17 quad_perm:[1,1,1,1] row_mask:0xf bank_mask:0xf
    v_add_f32_dpp v15, v43, v15 quad_perm:[3,3,3,3] row_mask:0xf bank_mask:0xf
    v_add_f32 v17, v17, v15
    s_waitcnt vmcnt(13)
    v_mfma_f32_16x16x32_bf16 v[36:39], v[204:207], v[32:35], 0
    s_waitcnt vmcnt(4)
    buffer_load_dwordx4 v[100:103], v8, s[52:55], s93 offen offset:1024 nt
    v_mov_b32_dpp v18, v44 quad_perm:[0,0,0,0] row_mask:0xf bank_mask:0xf
    v_mov_b32_dpp v15, v46 quad_perm:[2,2,2,2] row_mask:0xf bank_mask:0xf
    s_nop 0
    v_add_f32_dpp v18, v45, v18 quad_perm:[1,1,1,1] row_mask:0xf bank_mask:0xf
    v_add_f32_dpp v15, v47, v15 quad_perm:[3,3,3,3] row_mask:0xf bank_mask:0xf
    v_add_f32 v18, v18, v15
    s_nop 1
    v_mov_b32_dpp v19, v36 quad_perm:[0,0,0,0] row_mask:0xf bank_mask:0xf
    v_mov_b32_dpp v15, v38 quad_perm:[2,2,2,2] row_mask:0xf bank_mask:0xf
    s_nop 0
    v_add_f32_dpp v19, v37, v19 quad_perm:[1,1,1,1] row_mask:0xf bank_mask:0xf
    v_add_f32_dpp v15, v39, v15 quad_perm:[3,3,3,3] row_mask:0xf bank_mask:0xf
    v_add_f32 v19, v19, v15
    v_cvt_pk_bf16_f32 v13, v16, v17
    v_cvt_pk_bf16_f32 v14, v18, v19
    v_lshlrev_b32 v16, 16, v13
    v_and_b32 v17, s8, v13
    v_lshlrev_b32 v18, 16, v14
    v_and_b32 v19, s8, v14
    v_mul_f32 v16, s9, v16
    v_mul_f32 v17, s9, v17
    v_mul_f32 v18, s9, v18
    v_mul_f32 v19, s9, v19
    v_cvt_pk_bf16_f32 v13, v16, v17
    v_cvt_pk_bf16_f32 v14, v18, v19
    v_lshlrev_b32 v16, 16, v13
    v_and_b32 v17, s8, v13
    v_lshlrev_b32 v18, 16, v14
    v_and_b32 v19, s8, v14
    v_max3_f32 v13, v16, v17, v18
    v_max3_f32 v13, v13, v19, v10
    v_mov_b32 v14, v13
    s_nop 1
    v_permlane32_swap_b32 v14, v13
    v_max_f32 v13, v13, v14
    v_mov_b32 v14, v13
    s_nop 1
    v_permlane16_swap_b32 v14, v13
    v_max_f32 v12, v13, v14
    v_sub_f32 v15, v10, v12
    v_pk_add_f32 v[16:17], v[16:17], v[12:13] op_sel_hi:[1,0] neg_lo:[0,1] neg_hi:[0,1]
    v_pk_add_f32 v[18:19], v[18:19], v[12:13] op_sel_hi:[1,0] neg_lo:[0,1] neg_hi:[0,1]
    v_mul_f32 v15, s10, v15
    v_pk_mul_f32 v[16:17], v[16:17], s[10:11] op_sel_hi:[1,0]
    v_pk_mul_f32 v[18:19], v[18:19], s[10:11] op_sel_hi:[1,0]
    v_exp_f32 v15, v15
    v_exp_f32 v16, v16
    v_exp_f32 v17, v17
    v_exp_f32 v18, v18
    v_exp_f32 v19, v19
    v_mov_b32 v10, v12
    v_mul_f32 v20, v20, v15
    v_mul_f32 v21, v21, v15
    v_mul_f32 v22, v22, v15
    v_mul_f32 v23, v23, v15
    v_fma_f32 v11, v11, v15, v16
    v_add_f32 v13, v17, v18
    v_add_f32 v11, v11, v19
    v_cvt_pk_bf16_f32 v16, v16, v16
    v_cvt_pk_bf16_f32 v17, v17, v17
    v_cvt_pk_bf16_f32 v18, v18, v18
    v_cvt_pk_bf16_f32 v19, v19, v19
    v_add_f32 v11, v11, v13
    v_and_b32 v24, v16, v4
    v_and_b32 v25, v16, v5
    v_and_b32 v26, v16, v6
    v_and_b32 v27, v16, v7
    v_and_b32 v28, v17, v4
    v_and_b32 v29, v17, v5
    v_and_b32 v30, v17, v6
    v_and_b32 v31, v17, v7
    v_and_b32 v36, v18, v4
    v_and_b32 v37, v18, v5
    v_and_b32 v38, v18, v6
    v_and_b32 v39, v18, v7
    v_and_b32 v40, v19, v4
    v_and_b32 v41, v19, v5
    v_and_b32 v42, v19, v6
    v_and_b32 v43, v19, v7
    s_waitcnt vmcnt(13)
    v_mfma_f32_16x16x32_bf16 v[20:23], v[208:211], v[24:27], v[20:23]
    s_waitcnt vmcnt(12)
    v_mfma_f32_16x16x32_bf16 v[20:23], v[212:215], v[28:31], v[20:23]
    s_waitcnt vmcnt(4)
    buffer_load_dwordx4 v[104:107], v8, s[52:55], s93 offen offset:2048 nt
    s_waitcnt vmcnt(12)
    v_mfma_f32_16x16x32_bf16 v[20:23], v[216:219], v[36:39], v[20:23]
    s_waitcnt vmcnt(11)
    v_mfma_f32_16x16x32_bf16 v[20:23], v[220:223], v[40:43], v[20:23]
    s_waitcnt vmcnt(4)
    buffer_load_dwordx4 v[108:111], v8, s[52:55], s93 offen offset:3072 nt
    s_waitcnt vmcnt(11)
    v_mfma_f32_16x16x32_bf16 v[36:39], v[224:227], v[32:35], 0
    s_waitcnt vmcnt(10)
    v_mfma_f32_16x16x32_bf16 v[40:43], v[228:231], v[32:35], 0
    s_waitcnt vmcnt(4)
    buffer_load_dwordx4 v[112:115], v60, s[56:59], s93 offen offset:0 nt
    s_nop 5
    v_mov_b32_dpp v16, v36 quad_perm:[0,0,0,0] row_mask:0xf bank_mask:0xf
    v_mov_b32_dpp v15, v38 quad_perm:[2,2,2,2] row_mask:0xf bank_mask:0xf
    s_nop 0
    v_add_f32_dpp v16, v37, v16 quad_perm:[1,1,1,1] row_mask:0xf bank_mask:0xf
    v_add_f32_dpp v15, v39, v15 quad_perm:[3,3,3,3] row_mask:0xf bank_mask:0xf
    v_add_f32 v16, v16, v15
    s_waitcnt vmcnt(10)
    v_mfma_f32_16x16x32_bf16 v[44:47], v[232:235], v[32:35], 0
    v_mov_b32_dpp v17, v40 quad_perm:[0,0,0,0] row_mask:0xf bank_mask:0xf
    v_mov_b32_dpp v15, v42 quad_perm:[2,2,2,2] row_mask:0xf bank_mask:0xf
    s_nop 0
    v_add_f32_dpp v17, v41, v17 quad_perm:[1,1,1,1] row_mask:0xf bank_mask:0xf
    v_add_f32_dpp v15, v43, v15 quad_perm:[3,3,3,3] row_mask:0xf bank_mask:0xf
    v_add_f32 v17, v17, v15
    s_waitcnt vmcnt(9)
    v_mfma_f32_16x16x32_bf16 v[36:39], v[236:239], v[32:35], 0
    s_waitcnt vmcnt(4)
    buffer_load_dwordx4 v[116:119], v60, s[56:59], s93 offen offset:1024 nt
    v_mov_b32_dpp v18, v44 quad_perm:[0,0,0,0] row_mask:0xf bank_mask:0xf
    v_mov_b32_dpp v15, v46 quad_perm:[2,2,2,2] row_mask:0xf bank_mask:0xf
    s_nop 0
    v_add_f32_dpp v18, v45, v18 quad_perm:[1,1,1,1] row_mask:0xf bank_mask:0xf
    v_add_f32_dpp v15, v47, v15 quad_perm:[3,3,3,3] row_mask:0xf bank_mask:0xf
    v_add_f32 v18, v18, v15
    s_nop 1
    v_mov_b32_dpp v19, v36 quad_perm:[0,0,0,0] row_mask:0xf bank_mask:0xf
    v_mov_b32_dpp v15, v38 quad_perm:[2,2,2,2] row_mask:0xf bank_mask:0xf
    s_nop 0
    v_add_f32_dpp v19, v37, v19 quad_perm:[1,1,1,1] row_mask:0xf bank_mask:0xf
    v_add_f32_dpp v15, v39, v15 quad_perm:[3,3,3,3] row_mask:0xf bank_mask:0xf
    v_add_f32 v19, v19, v15
    v_cvt_pk_bf16_f32 v13, v16, v17
    v_cvt_pk_bf16_f32 v14, v18, v19
    v_lshlrev_b32 v16, 16, v13
    v_and_b32 v17, s8, v13
    v_lshlrev_b32 v18, 16, v14
    v_and_b32 v19, s8, v14
    v_mul_f32 v16, s9, v16
    v_mul_f32 v17, s9, v17
    v_mul_f32 v18, s9, v18
    v_mul_f32 v19, s9, v19
    v_cvt_pk_bf16_f32 v13, v16, v17
    v_cvt_pk_bf16_f32 v14, v18, v19
    v_lshlrev_b32 v16, 16, v13
    v_and_b32 v17, s8, v13
    v_lshlrev_b32 v18, 16, v14
    v_and_b32 v19, s8, v14
    v_max3_f32 v13, v16, v17, v18
    v_max3_f32 v13, v13, v19, v10
    v_mov_b32 v14, v13
    s_nop 1
    v_permlane32_swap_b32 v14, v13
    v_max_f32 v13, v13, v14
    v_mov_b32 v14, v13
    s_nop 1
    v_permlane16_swap_b32 v14, v13
    v_max_f32 v12, v13, v14
    v_sub_f32 v15, v10, v12
    v_pk_add_f32 v[16:17], v[16:17], v[12:13] op_sel_hi:[1,0] neg_lo:[0,1] neg_hi:[0,1]
    v_pk_add_f32 v[18:19], v[18:19], v[12:13] op_sel_hi:[1,0] neg_lo:[0,1] neg_hi:[0,1]
    v_mul_f32 v15, s10, v15
    v_pk_mul_f32 v[16:17], v[16:17], s[10:11] op_sel_hi:[1,0]
    v_pk_mul_f32 v[18:19], v[18:19], s[10:11] op_sel_hi:[1,0]
    v_exp_f32 v15, v15
    v_exp_f32 v16, v16
    v_exp_f32 v17, v17
    v_exp_f32 v18, v18
    v_exp_f32 v19, v19
    v_mov_b32 v10, v12
    v_mul_f32 v20, v20, v15
    v_mul_f32 v21, v21, v15
    v_mul_f32 v22, v22, v15
    v_mul_f32 v23, v23, v15
    v_fma_f32 v11, v11, v15, v16
    v_add_f32 v13, v17, v18
    v_add_f32 v11, v11, v19
    v_cvt_pk_bf16_f32 v16, v16, v16
    v_cvt_pk_bf16_f32 v17, v17, v17
    v_cvt_pk_bf16_f32 v18, v18, v18
    v_cvt_pk_bf16_f32 v19, v19, v19
    v_add_f32 v11, v11, v13
    v_and_b32 v24, v16, v4
    v_and_b32 v25, v16, v5
    v_and_b32 v26, v16, v6
    v_and_b32 v27, v16, v7
    v_and_b32 v28, v17, v4
    v_and_b32 v29, v17, v5
    v_and_b32 v30, v17, v6
    v_and_b32 v31, v17, v7
    v_and_b32 v36, v18, v4
    v_and_b32 v37, v18, v5
    v_and_b32 v38, v18, v6
    v_and_b32 v39, v18, v7
    v_and_b32 v40, v19, v4
    v_and_b32 v41, v19, v5
    v_and_b32 v42, v19, v6
    v_and_b32 v43, v19, v7
    s_waitcnt vmcnt(9)
    v_mfma_f32_16x16x32_bf16 v[20:23], v[240:243], v[24:27], v[20:23]
    s_waitcnt vmcnt(8)
    v_mfma_f32_16x16x32_bf16 v[20:23], v[244:247], v[28:31], v[20:23]
    s_waitcnt vmcnt(4)
    buffer_load_dwordx4 v[120:123], v60, s[56:59], s93 offen offset:2048 nt
    s_waitcnt vmcnt(8)
    v_mfma_f32_16x16x32_bf16 v[20:23], v[248:251], v[36:39], v[20:23]
    s_waitcnt vmcnt(7)
    v_mfma_f32_16x16x32_bf16 v[20:23], v[252:255], v[40:43], v[20:23]
    s_waitcnt vmcnt(4)
    buffer_load_dwordx4 v[124:127], v60, s[56:59], s93 offen offset:3072 nt
    s_waitcnt vmcnt(7)
    v_mfma_f32_16x16x32_bf16 v[36:39], v[96:99], v[32:35], 0
    s_waitcnt vmcnt(6)
    v_mfma_f32_16x16x32_bf16 v[40:43], v[100:103], v[32:35], 0
    s_nop 5
    v_mov_b32_dpp v16, v36 quad_perm:[0,0,0,0] row_mask:0xf bank_mask:0xf
    v_mov_b32_dpp v15, v38 quad_perm:[2,2,2,2] row_mask:0xf bank_mask:0xf
    s_nop 0
    v_add_f32_dpp v16, v37, v16 quad_perm:[1,1,1,1] row_mask:0xf bank_mask:0xf
    v_add_f32_dpp v15, v39, v15 quad_perm:[3,3,3,3] row_mask:0xf bank_mask:0xf
    v_add_f32 v16, v16, v15
    s_waitcnt vmcnt(5)
    v_mfma_f32_16x16x32_bf16 v[44:47], v[104:107], v[32:35], 0
    v_mov_b32_dpp v17, v40 quad_perm:[0,0,0,0] row_mask:0xf bank_mask:0xf
    v_mov_b32_dpp v15, v42 quad_perm:[2,2,2,2] row_mask:0xf bank_mask:0xf
    s_nop 0
    v_add_f32_dpp v17, v41, v17 quad_perm:[1,1,1,1] row_mask:0xf bank_mask:0xf
    v_add_f32_dpp v15, v43, v15 quad_perm:[3,3,3,3] row_mask:0xf bank_mask:0xf
    v_add_f32 v17, v17, v15
    s_waitcnt vmcnt(4)
    v_mfma_f32_16x16x32_bf16 v[36:39], v[108:111], v[32:35], 0
    s_add_u32 s68, s68, 131072
    s_xor_b32 s93, s68, s91
    s_waitcnt vmcnt(4)
    buffer_load_dwordx4 v[128:131], v8, s[52:55], s93 offen offset:0 nt
    v_mov_b32_dpp v18, v44 quad_perm:[0,0,0,0] row_mask:0xf bank_mask:0xf
    v_mov_b32_dpp v15, v46 quad_perm:[2,2,2,2] row_mask:0xf bank_mask:0xf
    s_nop 0
    v_add_f32_dpp v18, v45, v18 quad_perm:[1,1,1,1] row_mask:0xf bank_mask:0xf
    v_add_f32_dpp v15, v47, v15 quad_perm:[3,3,3,3] row_mask:0xf bank_mask:0xf
    v_add_f32 v18, v18, v15
    s_nop 1
    v_mov_b32_dpp v19, v36 quad_perm:[0,0,0,0] row_mask:0xf bank_mask:0xf
    v_mov_b32_dpp v15, v38 quad_perm:[2,2,2,2] row_mask:0xf bank_mask:0xf
    s_nop 0
    v_add_f32_dpp v19, v37, v19 quad_perm:[1,1,1,1] row_mask:0xf bank_mask:0xf
    v_add_f32_dpp v15, v39, v15 quad_perm:[3,3,3,3] row_mask:0xf bank_mask:0xf
    v_add_f32 v19, v19, v15
    v_cvt_pk_bf16_f32 v13, v16, v17
    v_cvt_pk_bf16_f32 v14, v18, v19
    v_lshlrev_b32 v16, 16, v13
    v_and_b32 v17, s8, v13
    v_lshlrev_b32 v18, 16, v14
    v_and_b32 v19, s8, v14
    v_mul_f32 v16, s9, v16
    v_mul_f32 v17, s9, v17
    v_mul_f32 v18, s9, v18
    v_mul_f32 v19, s9, v19
    v_cvt_pk_bf16_f32 v13, v16, v17
    v_cvt_pk_bf16_f32 v14, v18, v19
    v_lshlrev_b32 v16, 16, v13
    v_and_b32 v17, s8, v13
    v_lshlrev_b32 v18, 16, v14
    v_and_b32 v19, s8, v14
    v_max3_f32 v13, v16, v17, v18
    v_max3_f32 v13, v13, v19, v10
    v_mov_b32 v14, v13
    s_nop 1
    v_permlane32_swap_b32 v14, v13
    v_max_f32 v13, v13, v14
    v_mov_b32 v14, v13
    s_nop 1
    v_permlane16_swap_b32 v14, v13
    v_max_f32 v12, v13, v14
    v_sub_f32 v15, v10, v12
    v_pk_add_f32 v[16:17], v[16:17], v[12:13] op_sel_hi:[1,0] neg_lo:[0,1] neg_hi:[0,1]
    v_pk_add_f32 v[18:19], v[18:19], v[12:13] op_sel_hi:[1,0] neg_lo:[0,1] neg_hi:[0,1]
    v_mul_f32 v15, s10, v15
    v_pk_mul_f32 v[16:17], v[16:17], s[10:11] op_sel_hi:[1,0]
    v_pk_mul_f32 v[18:19], v[18:19], s[10:11] op_sel_hi:[1,0]
    v_exp_f32 v15, v15
    v_exp_f32 v16, v16
    v_exp_f32 v17, v17
    v_exp_f32 v18, v18
    v_exp_f32 v19, v19
    v_mov_b32 v10, v12
    v_mul_f32 v20, v20, v15
    v_mul_f32 v21, v21, v15
    v_mul_f32 v22, v22, v15
    v_mul_f32 v23, v23, v15
    v_fma_f32 v11, v11, v15, v16
    v_add_f32 v13, v17, v18
    v_add_f32 v11, v11, v19
    v_cvt_pk_bf16_f32 v16, v16, v16
    v_cvt_pk_bf16_f32 v17, v17, v17
    v_cvt_pk_bf16_f32 v18, v18, v18
    v_cvt_pk_bf16_f32 v19, v19, v19
    v_add_f32 v11, v11, v13
    v_and_b32 v24, v16, v4
    v_and_b32 v25, v16, v5
    v_and_b32 v26, v16, v6
    v_and_b32 v27, v16, v7
    v_and_b32 v28, v17, v4
    v_and_b32 v29, v17, v5
    v_and_b32 v30, v17, v6
    v_and_b32 v31, v17, v7
    v_and_b32 v36, v18, v4
    v_and_b32 v37, v18, v5
    v_and_b32 v38, v18, v6
    v_and_b32 v39, v18, v7
    v_and_b32 v40, v19, v4
    v_and_b32 v41, v19, v5
    v_and_b32 v42, v19, v6
    v_and_b32 v43, v19, v7
    s_waitcnt vmcnt(4)
    v_mfma_f32_16x16x32_bf16 v[20:23], v[112:115], v[24:27], v[20:23]
    s_waitcnt vmcnt(4)
    buffer_load_dwordx4 v[132:135], v8, s[52:55], s93 offen offset:1024 nt
    s_waitcnt vmcnt(4)
    v_mfma_f32_16x16x32_bf16 v[20:23], v[116:119], v[28:31], v[20:23]
    s_waitcnt vmcnt(4)
    buffer_load_dwordx4 v[136:139], v8, s[52:55], s93 offen offset:2048 nt
    s_waitcnt vmcnt(4)
    v_mfma_f32_16x16x32_bf16 v[20:23], v[120:123], v[36:39], v[20:23]
    s_waitcnt vmcnt(4)
    buffer_load_dwordx4 v[140:143], v8, s[52:55], s93 offen offset:3072 nt
    s_waitcnt vmcnt(4)
    v_mfma_f32_16x16x32_bf16 v[20:23], v[124:127], v[40:43], v[20:23]
    s_waitcnt vmcnt(4)
    buffer_load_dwordx4 v[144:147], v60, s[56:59], s93 offen offset:0 nt
    s_lshl_b32 s68, s6, 14
    s_add_u32 s68, s68, 917504
    s_mov_b32 s69, 480
    s_mov_b64 exec, 1
    ds_add_rtn_u32 v58, v63, v59 offset:8
    s_mov_b64 exec, -1
    s_waitcnt lgkmcnt(0)
    v_readfirstlane_b32 s94, v58
    s_lshr_b32 s13, s94, 2
    s_lshl_b32 s13, s13, 17
    s_and_b32 s92, s94, 3
    s_lshl_b32 s92, s92, 12
    s_add_u32 s13, s13, s92
    s_add_u32 s13, s13, s68
    s_xor_b32 s13, s13, s91
    s_cmp_lt_u32 s94, 32
    s_cbranch_scc1 L_loop
    s_mov_b32 s14, 1
    s_mov_b32 s94, 1
    s_atomic_add s94, s[42:43], s95 glc
L_loop:
    s_waitcnt vmcnt(4)
    v_mfma_f32_16x16x32_bf16 v[36:39], v[128:131], v[32:35], 0
    buffer_load_dwordx4 v[148:151], v60, s[56:59], s93 offen offset:1024 nt
    s_waitcnt vmcnt(4)
    v_mfma_f32_16x16x32_bf16 v[40:43], v[132:135], v[32:35], 0
    buffer_load_dwordx4 v[152:155], v60, s[56:59], s93 offen offset:2048 nt
    s_nop 5
    v_mov_b32_dpp v16, v36 quad_perm:[0,0,0,0] row_mask:0xf bank_mask:0xf
    v_mov_b32_dpp v15, v38 quad_perm:[2,2,2,2] row_mask:0xf bank_mask:0xf
    s_nop 0
    v_add_f32_dpp v16, v37, v16 quad_perm:[1,1,1,1] row_mask:0xf bank_mask:0xf
    v_add_f32_dpp v15, v39, v15 quad_perm:[3,3,3,3] row_mask:0xf bank_mask:0xf
    v_add_f32 v16, v16, v15
    s_waitcnt vmcnt(4)
    v_mfma_f32_16x16x32_bf16 v[44:47], v[136:139], v[32:35], 0
    buffer_load_dwordx4 v[156:159], v60, s[56:59], s93 offen offset:3072 nt
    v_mov_b32_dpp v17, v40 quad_perm:[0,0,0,0] row_mask:0xf bank_mask:0xf
    v_mov_b32_dpp v15, v42 quad_perm:[2,2,2,2] row_mask:0xf bank_mask:0xf
    s_nop 0
    v_add_f32_dpp v17, v41, v17 quad_perm:[1,1,1,1] row_mask:0xf bank_mask:0xf
    v_add_f32_dpp v15, v43, v15 quad_perm:[3,3,3,3] row_mask:0xf bank_mask:0xf
    v_add_f32 v17, v17, v15
    s_waitcnt vmcnt(4)
    v_mfma_f32_16x16x32_bf16 v[36:39], v[140:143], v[32:35], 0
    s_mov_b32 s93, s13
    s_cmp_eq_u32 s14, 0
    s_cbranch_scc0 L_gd
    buffer_load_dwordx4 v[128:131], v8, s[52:55], s93 offen offset:0 nt
    s_mov_b64 exec, 1
    ds_add_rtn_u32 v58, v63, v59 offset:8
    s_mov_b64 exec, -1
L_kn:
    v_mov_b32_dpp v18, v44 quad_perm:[0,0,0,0] row_mask:0xf bank_mask:0xf
    v_mov_b32_dpp v15, v46 quad_perm:[2,2,2,2] row_mask:0xf bank_mask:0xf
    s_nop 0
    v_add_f32_dpp v18, v45, v18 quad_perm:[1,1,1,1] row_mask:0xf bank_mask:0xf
    v_add_f32_dpp v15, v47, v15 quad_perm:[3,3,3,3] row_mask:0xf bank_mask:0xf
    v_add_f32 v18, v18, v15
    s_nop 1
    v_mov_b32_dpp v19, v36 quad_perm:[0,0,0,0] row_mask:0xf bank_mask:0xf
    v_mov_b32_dpp v15, v38 quad_perm:[2,2,2,2] row_mask:0xf bank_mask:0xf
    s_nop 0
    v_add_f32_dpp v19, v37, v19 quad_perm:[1,1,1,1] row_mask:0xf bank_mask:0xf
    v_add_f32_dpp v15, v39, v15 quad_perm:[3,3,3,3] row_mask:0xf bank_mask:0xf
    v_add_f32 v19, v19, v15
    v_cvt_pk_bf16_f32 v13, v16, v17
    v_cvt_pk_bf16_f32 v14, v18, v19
    v_lshlrev_b32 v16, 16, v13
    v_and_b32 v17, s8, v13
    v_lshlrev_b32 v18, 16, v14
    v_and_b32 v19, s8, v14
    v_mul_f32 v16, s9, v16
    v_mul_f32 v17, s9, v17
    v_mul_f32 v18, s9, v18
    v_mul_f32 v19, s9, v19
    v_cvt_pk_bf16_f32 v13, v16, v17
    v_cvt_pk_bf16_f32 v14, v18, v19
    v_lshlrev_b32 v16, 16, v13
    v_and_b32 v17, s8, v13
    v_lshlrev_b32 v18, 16, v14
    v_and_b32 v19, s8, v14
    v_max3_f32 v13, v16, v17, v18
    v_max3_f32 v13, v13, v19, v10
    v_mov_b32 v14, v13
    s_nop 1
    v_permlane32_swap_b32 v14, v13
    v_max_f32 v13, v13, v14
    v_mov_b32 v14, v13
    s_nop 1
    v_permlane16_swap_b32 v14, v13
    v_max_f32 v12, v13, v14
    v_sub_f32 v15, v10, v12
    v_pk_add_f32 v[16:17], v[16:17], v[12:13] op_sel_hi:[1,0] neg_lo:[0,1] neg_hi:[0,1]
    v_pk_add_f32 v[18:19], v[18:19], v[12:13] op_sel_hi:[1,0] neg_lo:[0,1] neg_hi:[0,1]
    v_mul_f32 v15, s10, v15
    v_pk_mul_f32 v[16:17], v[16:17], s[10:11] op_sel_hi:[1,0]
    v_pk_mul_f32 v[18:19], v[18:19], s[10:11] op_sel_hi:[1,0]
    v_exp_f32 v15, v15
    v_exp_f32 v16, v16
    v_exp_f32 v17, v17
    v_exp_f32 v18, v18
    v_exp_f32 v19, v19
    v_mov_b32 v10, v12
    v_mul_f32 v20, v20, v15
    v_mul_f32 v21, v21, v15
    v_mul_f32 v22, v22, v15
    v_mul_f32 v23, v23, v15
    v_fma_f32 v11, v11, v15, v16
    v_add_f32 v13, v17, v18
    v_add_f32 v11, v11, v19
    v_cvt_pk_bf16_f32 v16, v16, v16
    v_cvt_pk_bf16_f32 v17, v17, v17
    v_cvt_pk_bf16_f32 v18, v18, v18
    v_cvt_pk_bf16_f32 v19, v19, v19
    v_add_f32 v11, v11, v13
    s_cmp_eq_u32 s14, 0
    s_cbranch_scc0 L_c
    s_waitcnt lgkmcnt(0)
    v_readfirstlane_b32 s94, v58
    s_lshr_b32 s13, s94, 2
    s_lshl_b32 s13, s13, 17
    s_and_b32 s92, s94, 3
    s_lshl_b32 s92, s92, 12
    s_add_u32 s13, s13, s92
    s_add_u32 s13, s13, s68
    s_xor_b32 s13, s13, s91
    s_cmp_lt_u32 s94, 32
    s_cbranch_scc1 L_c
    s_mov_b32 s14, 1
    s_mov_b32 s94, 1
    s_atomic_add s94, s[42:43], s95 glc
L_c:
    v_and_b32 v24, v16, v4
    v_and_b32 v25, v16, v5
    v_and_b32 v26, v16, v6
    v_and_b32 v27, v16, v7
    v_and_b32 v28, v17, v4
    v_and_b32 v29, v17, v5
    v_and_b32 v30, v17, v6
    v_and_b32 v31, v17, v7
    v_and_b32 v36, v18, v4
    v_and_b32 v37, v18, v5
    v_and_b32 v38, v18, v6
    v_and_b32 v39, v18, v7
    v_and_b32 v40, v19, v4
    v_and_b32 v41, v19, v5
    v_and_b32 v42, v19, v6
    v_and_b32 v43, v19, v7
    s_waitcnt vmcnt(4)
    v_mfma_f32_16x16x32_bf16 v[20:23], v[144:147], v[24:27], v[20:23]
    buffer_load_dwordx4 v[132:135], v8, s[52:55], s93 offen offset:1024 nt
    s_waitcnt vmcnt(4)
    v_mfma_f32_16x16x32_bf16 v[20:23], v[148:151], v[28:31], v[20:23]
    buffer_load_dwordx4 v[136:139], v8, s[52:55], s93 offen offset:2048 nt
    s_waitcnt vmcnt(4)
    v_mfma_f32_16x16x32_bf16 v[20:23], v[152:155], v[36:39], v[20:23]
    buffer_load_dwordx4 v[140:143], v8, s[52:55], s93 offen offset:3072 nt
    s_waitcnt vmcnt(4)
    v_mfma_f32_16x16x32_bf16 v[20:23], v[156:159], v[40:43], v[20:23]
    buffer_load_dwordx4 v[144:147], v60, s[56:59], s93 offen offset:0 nt
    s_branch L_loop
L_gd:
    s_waitcnt lgkmcnt(0)
    s_lshl_b32 s93, s94, 0
    s_add_u32 s93, s93, s69
    s_lshl_b32 s93, s93, 12
    s_xor_b32 s93, s93, s91
    s_cmp_lt_u32 s94, 32
    s_cbranch_scc0 L_x
    buffer_load_dwordx4 v[128:131], v8, s[52:55], s93 offen offset:0 nt
    buffer_load_dwordx4 v[132:135], v8, s[52:55], s93 offen offset:1024 nt
    buffer_load_dwordx4 v[136:139], v8, s[52:55], s93 offen offset:2048 nt
    buffer_load_dwordx4 v[140:143], v8, s[52:55], s93 offen offset:3072 nt
    s_mov_b32 s94, 1
    s_atomic_add s94, s[42:43], s95 glc
    v_mov_b32_dpp v18, v44 quad_perm:[0,0,0,0] row_mask:0xf bank_mask:0xf
    v_mov_b32_dpp v15, v46 quad_perm:[2,2,2,2] row_mask:0xf bank_mask:0xf
    s_nop 0
    v_add_f32_dpp v18, v45, v18 quad_perm:[1,1,1,1] row_mask:0xf bank_mask:0xf
    v_add_f32_dpp v15, v47, v15 quad_perm:[3,3,3,3] row_mask:0xf bank_mask:0xf
    v_add_f32 v18, v18, v15
    s_nop 1
    v_mov_b32_dpp v19, v36 quad_perm:[0,0,0,0] row_mask:0xf bank_mask:0xf
    v_mov_b32_dpp v15, v38 quad_perm:[2,2,2,2] row_mask:0xf bank_mask:0xf
    s_nop 0
    v_add_f32_dpp v19, v37, v19 quad_perm:[1,1,1,1] row_mask:0xf bank_mask:0xf
    v_add_f32_dpp v15, v39, v15 quad_perm:[3,3,3,3] row_mask:0xf bank_mask:0xf
    v_add_f32 v19, v19, v15
    v_cvt_pk_bf16_f32 v13, v16, v17
    v_cvt_pk_bf16_f32 v14, v18, v19
    v_lshlrev_b32 v16, 16, v13
    v_and_b32 v17, s8, v13
    v_lshlrev_b32 v18, 16, v14
    v_and_b32 v19, s8, v14
    v_mul_f32 v16, s9, v16
    v_mul_f32 v17, s9, v17
    v_mul_f32 v18, s9, v18
    v_mul_f32 v19, s9, v19
    v_cvt_pk_bf16_f32 v13, v16, v17
    v_cvt_pk_bf16_f32 v14, v18, v19
    v_lshlrev_b32 v16, 16, v13
    v_and_b32 v17, s8, v13
    v_lshlrev_b32 v18, 16, v14
    v_and_b32 v19, s8, v14
    v_max3_f32 v13, v16, v17, v18
    v_max3_f32 v13, v13, v19, v10
    v_mov_b32 v14, v13
    s_nop 1
    v_permlane32_swap_b32 v14, v13
    v_max_f32 v13, v13, v14
    v_mov_b32 v14, v13
    s_nop 1
    v_permlane16_swap_b32 v14, v13
    v_max_f32 v12, v13, v14
    v_sub_f32 v15, v10, v12
    v_pk_add_f32 v[16:17], v[16:17], v[12:13] op_sel_hi:[1,0] neg_lo:[0,1] neg_hi:[0,1]
    v_pk_add_f32 v[18:19], v[18:19], v[12:13] op_sel_hi:[1,0] neg_lo:[0,1] neg_hi:[0,1]
    v_mul_f32 v15, s10, v15
    v_pk_mul_f32 v[16:17], v[16:17], s[10:11] op_sel_hi:[1,0]
    v_pk_mul_f32 v[18:19], v[18:19], s[10:11] op_sel_hi:[1,0]
    v_exp_f32 v15, v15
    v_exp_f32 v16, v16
    v_exp_f32 v17, v17
    v_exp_f32 v18, v18
    v_exp_f32 v19, v19
    v_mov_b32 v10, v12
    v_mul_f32 v20, v20, v15
    v_mul_f32 v21, v21, v15
    v_mul_f32 v22, v22, v15
    v_mul_f32 v23, v23, v15
    v_fma_f32 v11, v11, v15, v16
    v_add_f32 v13, v17, v18
    v_add_f32 v11, v11, v19
    v_cvt_pk_bf16_f32 v16, v16, v16
    v_cvt_pk_bf16_f32 v17, v17, v17
    v_cvt_pk_bf16_f32 v18, v18, v18
    v_cvt_pk_bf16_f32 v19, v19, v19
    v_add_f32 v11, v11, v13
    v_and_b32 v24, v16, v4
    v_and_b32 v25, v16, v5
    v_and_b32 v26, v16, v6
    v_and_b32 v27, v16, v7
    v_and_b32 v28, v17, v4
    v_and_b32 v29, v17, v5
    v_and_b32 v30, v17, v6
    v_and_b32 v31, v17, v7
    v_and_b32 v36, v18, v4
    v_and_b32 v37, v18, v5
    v_and_b32 v38, v18, v6
    v_and_b32 v39, v18, v7
    v_and_b32 v40, v19, v4
    v_and_b32 v41, v19, v5
    v_and_b32 v42, v19, v6
    v_and_b32 v43, v19, v7
    s_waitcnt vmcnt(7)
    v_mfma_f32_16x16x32_bf16 v[20:23], v[144:147], v[24:27], v[20:23]
    buffer_load_dwordx4 v[144:147], v60, s[56:59], s93 offen offset:0 nt
    s_waitcnt vmcnt(7)
    v_mfma_f32_16x16x32_bf16 v[20:23], v[148:151], v[28:31], v[20:23]
    buffer_load_dwordx4 v[148:151], v60, s[56:59], s93 offen offset:1024 nt
    s_waitcnt vmcnt(7)
    v_mfma_f32_16x16x32_bf16 v[20:23], v[152:155], v[36:39], v[20:23]
    buffer_load_dwordx4 v[152:155], v60, s[56:59], s93 offen offset:2048 nt
    s_waitcnt vmcnt(7)
    v_mfma_f32_16x16x32_bf16 v[20:23], v[156:159], v[40:43], v[20:23]
    buffer_load_dwordx4 v[156:159], v60, s[56:59], s93 offen offset:3072 nt
    s_waitcnt vmcnt(7)
    v_mfma_f32_16x16x32_bf16 v[36:39], v[128:131], v[32:35], 0
    s_waitcnt vmcnt(6)
    v_mfma_f32_16x16x32_bf16 v[40:43], v[132:135], v[32:35], 0
    s_nop 5
    v_mov_b32_dpp v16, v36 quad_perm:[0,0,0,0] row_mask:0xf bank_mask:0xf
    v_mov_b32_dpp v15, v38 quad_perm:[2,2,2,2] row_mask:0xf bank_mask:0xf
    s_nop 0
    v_add_f32_dpp v16, v37, v16 quad_perm:[1,1,1,1] row_mask:0xf bank_mask:0xf
    v_add_f32_dpp v15, v39, v15 quad_perm:[3,3,3,3] row_mask:0xf bank_mask:0xf
    v_add_f32 v16, v16, v15
    s_waitcnt vmcnt(5)
    v_mfma_f32_16x16x32_bf16 v[44:47], v[136:139], v[32:35], 0
    v_mov_b32_dpp v17, v40 quad_perm:[0,0,0,0] row_mask:0xf bank_mask:0xf
    v_mov_b32_dpp v15, v42 quad_perm:[2,2,2,2] row_mask:0xf bank_mask:0xf
    s_nop 0
    v_add_f32_dpp v17, v41, v17 quad_perm:[1,1,1,1] row_mask:0xf bank_mask:0xf
    v_add_f32_dpp v15, v43, v15 quad_perm:[3,3,3,3] row_mask:0xf bank_mask:0xf
    v_add_f32 v17, v17, v15
    s_waitcnt vmcnt(4)
    v_mfma_f32_16x16x32_bf16 v[36:39], v[140:143], v[32:35], 0
    s_branch L_gd
L_x:
    buffer_load_dwordx4 v[64:67], v48, s[64:67], s70 offen offset:0
    buffer_load_dwordx4 v[68:71], v54, s[64:67], s70 offen offset:0
    buffer_load_dwordx4 v[72:75], v48, s[64:67], s70 offen offset:1152
    buffer_load_dwordx4 v[76:79], v54, s[64:67], s70 offen offset:1152
    buffer_load_dwordx4 v[80:83], v48, s[64:67], s70 offen offset:2304
    buffer_load_dwordx4 v[84:87], v54, s[64:67], s70 offen offset:2304
    buffer_load_dwordx4 v[88:91], v48, s[64:67], s70 offen offset:3456
    buffer_load_dwordx4 v[92:95], v54, s[64:67], s70 offen offset:3456
    s_addk_i32 s70, 9216
    v_mov_b32_dpp v18, v44 quad_perm:[0,0,0,0] row_mask:0xf bank_mask:0xf
    v_mov_b32_dpp v15, v46 quad_perm:[2,2,2,2] row_mask:0xf bank_mask:0xf
    s_nop 0
    v_add_f32_dpp v18, v45, v18 quad_perm:[1,1,1,1] row_mask:0xf bank_mask:0xf
    v_add_f32_dpp v15, v47, v15 quad_perm:[3,3,3,3] row_mask:0xf bank_mask:0xf
    v_add_f32 v18, v18, v15
    s_nop 1
    v_mov_b32_dpp v19, v36 quad_perm:[0,0,0,0] row_mask:0xf bank_mask:0xf
    v_mov_b32_dpp v15, v38 quad_perm:[2,2,2,2] row_mask:0xf bank_mask:0xf
    s_nop 0
    v_add_f32_dpp v19, v37, v19 quad_perm:[1,1,1,1] row_mask:0xf bank_mask:0xf
    v_add_f32_dpp v15, v39, v15 quad_perm:[3,3,3,3] row_mask:0xf bank_mask:0xf
    v_add_f32 v19, v19, v15
    v_cvt_pk_bf16_f32 v13, v16, v17
    v_cvt_pk_bf16_f32 v14, v18, v19
    v_lshlrev_b32 v16, 16, v13
    v_and_b32 v17, s8, v13
    v_lshlrev_b32 v18, 16, v14
    v_and_b32 v19, s8, v14
    v_mul_f32 v16, s9, v16
    v_mul_f32 v17, s9, v17
    v_mul_f32 v18, s9, v18
    v_mul_f32 v19, s9, v19
    v_cvt_pk_bf16_f32 v13, v16, v17
    v_cvt_pk_bf16_f32 v14, v18, v19
    v_lshlrev_b32 v16, 16, v13
    v_and_b32 v17, s8, v13
    v_lshlrev_b32 v18, 16, v14
    v_and_b32 v19, s8, v14
    v_max3_f32 v13, v16, v17, v18
    v_max3_f32 v13, v13, v19, v10
    v_mov_b32 v14, v13
    s_nop 1
    v_permlane32_swap_b32 v14, v13
    v_max_f32 v13, v13, v14
    v_mov_b32 v14, v13
    s_nop 1
    v_permlane16_swap_b32 v14, v13
    v_max_f32 v12, v13, v14
    v_sub_f32 v15, v10, v12
    v_pk_add_f32 v[16:17], v[16:17], v[12:13] op_sel_hi:[1,0] neg_lo:[0,1] neg_hi:[0,1]
    v_pk_add_f32 v[18:19], v[18:19], v[12:13] op_sel_hi:[1,0] neg_lo:[0,1] neg_hi:[0,1]
    v_mul_f32 v15, s10, v15
    v_pk_mul_f32 v[16:17], v[16:17], s[10:11] op_sel_hi:[1,0]
    v_pk_mul_f32 v[18:19], v[18:19], s[10:11] op_sel_hi:[1,0]
    v_exp_f32 v15, v15
    v_exp_f32 v16, v16
    v_exp_f32 v17, v17
    v_exp_f32 v18, v18
    v_exp_f32 v19, v19
    v_mov_b32 v10, v12
    v_mul_f32 v20, v20, v15
    v_mul_f32 v21, v21, v15
    v_mul_f32 v22, v22, v15
    v_mul_f32 v23, v23, v15
    v_fma_f32 v11, v11, v15, v16
    v_add_f32 v13, v17, v18
    v_add_f32 v11, v11, v19
    v_cvt_pk_bf16_f32 v16, v16, v16
    v_cvt_pk_bf16_f32 v17, v17, v17
    v_cvt_pk_bf16_f32 v18, v18, v18
    v_cvt_pk_bf16_f32 v19, v19, v19
    v_add_f32 v11, v11, v13
    v_mov_b32 v14, v11
    s_nop 1
    v_permlane32_swap_b32 v14, v11
    v_add_f32 v11, v11, v14
    v_mov_b32 v14, v11
    s_nop 1
    v_permlane16_swap_b32 v14, v11
    v_add_f32 v11, v11, v14
    ds_write_b64 v57, v[10:11] offset:4096
    v_and_b32 v24, v16, v4
    v_and_b32 v25, v16, v5
    v_and_b32 v26, v16, v6
    v_and_b32 v27, v16, v7
    v_and_b32 v28, v17, v4
    v_and_b32 v29, v17, v5
    v_and_b32 v30, v17, v6
    v_and_b32 v31, v17, v7
    v_and_b32 v36, v18, v4
    v_and_b32 v37, v18, v5
    v_and_b32 v38, v18, v6
    v_and_b32 v39, v18, v7
    v_and_b32 v40, v19, v4
    v_and_b32 v41, v19, v5
    v_and_b32 v42, v19, v6
    v_and_b32 v43, v19, v7
    s_waitcnt vmcnt(11)
    v_mfma_f32_16x16x32_bf16 v[20:23], v[144:147], v[24:27], v[20:23]
    s_waitcnt vmcnt(10)
    v_mfma_f32_16x16x32_bf16 v[20:23], v[148:151], v[28:31], v[20:23]
    s_waitcnt vmcnt(9)
    v_mfma_f32_16x16x32_bf16 v[20:23], v[152:155], v[36:39], v[20:23]
    s_waitcnt vmcnt(8)
    v_mfma_f32_16x16x32_bf16 v[20:23], v[156:159], v[40:43], v[20:23]
    s_nop 7
    ds_write_b128 v56, v[20:23] offset:10240
    s_waitcnt lgkmcnt(0)
    s_barrier
    s_barrier
    s_mov_b32 s12, 0xff00ff00
    s_mov_b32 s13, 0xff00ff00
    s_mov_b32 s11, 262144
    global_load_dwordx4 v[160:163], v50, s[42:43] offset:1024 sc1
    global_load_dwordx4 v[164:167], v49, s[42:43] sc1
    global_load_dwordx4 v[168:171], v0, s[42:43] sc1
    buffer_load_dwordx4 v[96:99], v48, s[64:67], s70 offen offset:0
    buffer_load_dwordx4 v[100:103], v54, s[64:67], s70 offen offset:0
    buffer_load_dwordx4 v[104:107], v48, s[64:67], s70 offen offset:1152
    buffer_load_dwordx4 v[108:111], v54, s[64:67], s70 offen offset:1152
    buffer_load_dwordx4 v[112:115], v48, s[64:67], s70 offen offset:2304
    buffer_load_dwordx4 v[116:119], v54, s[64:67], s70 offen offset:2304
    buffer_load_dwordx4 v[120:123], v48, s[64:67], s70 offen offset:3456
    buffer_load_dwordx4 v[124:127], v54, s[64:67], s70 offen offset:3456
    s_waitcnt vmcnt(10)
    v_xor_b32 v160, s96, v160
    v_xor_b32 v161, s97, v161
    v_xor_b32 v162, s98, v162
    v_xor_b32 v163, s99, v163
    v_or3_b32 v13, v160, v161, v162
    v_or_b32 v13, v13, v163
    s_waitcnt vmcnt(9)
    v_xor_b32 v164, s96, v164
    v_xor_b32 v165, s97, v165
    v_xor_b32 v166, s98, v166
    v_xor_b32 v167, s99, v167
    v_or3_b32 v13, v13, v164, v165
    v_or3_b32 v13, v13, v166, v167
    s_waitcnt vmcnt(8)
    v_xor_b32 v168, s96, v168
    v_xor_b32 v169, s97, v169
    v_xor_b32 v170, s98, v170
    v_xor_b32 v171, s99, v171
    v_or3_b32 v13, v13, v168, v169
    v_or3_b32 v13, v13, v170, v171
    v_and_b32 v13, v13, v62
    v_cmp_ne_u32 vcc, 0, v13
    s_cbranch_vccz L_p1_d
    s_mov_b64 exec, vcc
L_p1_loop:
    global_load_dwordx4 v[160:163], v50, s[42:43] offset:1024 sc1
    global_load_dwordx4 v[164:167], v49, s[42:43] sc1
    global_load_dwordx4 v[168:171], v0, s[42:43] sc1
L_p1_chk:
    s_waitcnt vmcnt(2)
    v_xor_b32 v160, s96, v160
    v_xor_b32 v161, s97, v161
    v_xor_b32 v162, s98, v162
    v_xor_b32 v163, s99, v163
    v_or3_b32 v13, v160, v161, v162
    v_or_b32 v13, v13, v163
    s_waitcnt vmcnt(1)
    v_xor_b32 v164, s96, v164
    v_xor_b32 v165, s97, v165
    v_xor_b32 v166, s98, v166
    v_xor_b32 v167, s99, v167
    v_or3_b32 v13, v13, v164, v165
    v_or3_b32 v13, v13, v166, v167
    s_waitcnt vmcnt(0)
    v_xor_b32 v168, s96, v168
    v_xor_b32 v169, s97, v169
    v_xor_b32 v170, s98, v170
    v_xor_b32 v171, s99, v171
    v_or3_b32 v13, v13, v168, v169
    v_or3_b32 v13, v13, v170, v171
    v_and_b32 v13, v13, v62
    v_cmp_ne_u32 vcc, 0, v13
    s_cbranch_vccz L_p1_d
    s_mov_b64 exec, vcc
    s_sub_u32 s11, s11, 1
    s_cmp_lg_u32 s11, 0
    s_cbranch_scc1 L_p1_loop
L_p1_d:
    s_mov_b64 exec, -1
    v_max_f32_dpp v8, v160, v160 row_ror:4 row_mask:0xf bank_mask:0xf
    s_nop 1
    v_max_f32_dpp v8, v8, v8 row_ror:8 row_mask:0xf bank_mask:0xf
    s_nop 0
    v_mov_b32 v9, v8
    s_nop 1
    v_permlane16_swap_b32 v9, v8
    v_max_f32 v8, v8, v9
    v_sub_f32 v8, v160, v8
    v_mul_f32 v8, s10, v8
    v_exp_f32 v8, v8
    s_nop 0
    v_mov_b32 v10, v8
    v_mul_f32 v161, v161, v8
    s_nop 0
    v_permlane32_swap_b32 v8, v10
    v_add_f32_dpp v161, v161, v161 row_ror:4 row_mask:0xf bank_mask:0xf
    v_pk_mul_f32 v[164:165], v[164:165], v[8:9] op_sel_hi:[1,0]
    v_pk_mul_f32 v[166:167], v[166:167], v[8:9] op_sel_hi:[1,0]
    v_add_f32_dpp v161, v161, v161 row_ror:8 row_mask:0xf bank_mask:0xf
    v_pk_mul_f32 v[168:169], v[168:169], v[10:11] op_sel_hi:[1,0]
    v_pk_mul_f32 v[170:171], v[170:171], v[10:11] op_sel_hi:[1,0]
    v_mov_b32 v162, v161
    v_permlane16_swap_b32 v164, v166
    v_permlane16_swap_b32 v165, v167
    v_permlane16_swap_b32 v162, v161
    v_permlane16_swap_b32 v168, v170
    v_permlane16_swap_b32 v169, v171
    v_add_f32 v161, v161, v162
    v_pk_add_f32 v[164:165], v[164:165], v[166:167]
    v_mov_b32 v162, v161
    v_pk_add_f32 v[168:169], v[168:169], v[170:171]
    v_add_f32_dpp v166, v164, v164 row_ror:8 row_mask:0xf bank_mask:0x3
    v_add_f32_dpp v167, v165, v165 row_ror:8 row_mask:0xf bank_mask:0x3
    v_permlane32_swap_b32 v161, v162
    v_add_f32_dpp v166, v168, v168 row_ror:8 row_mask:0xf bank_mask:0xc
    v_add_f32_dpp v167, v169, v169 row_ror:8 row_mask:0xf bank_mask:0xc
    v_cndmask_b32 v161, v161, v162, s[12:13]
    v_rcp_f32 v162, v161
    v_add_f32_dpp v164, v166, v166 row_shl:4 row_mask:0xf bank_mask:0x5
    v_add_f32_dpp v165, v167, v167 row_shl:4 row_mask:0xf bank_mask:0x5
    s_nop 0
    v_add_f32_dpp v164, v166, v166 row_shr:4 row_mask:0xf bank_mask:0xa
    v_add_f32_dpp v165, v167, v167 row_shr:4 row_mask:0xf bank_mask:0xa
    v_pk_mul_f32 v[164:165], v[164:165], v[162:163] op_sel_hi:[1,0]
    v_cvt_pk_bf16_f32 v164, v164, v164
    v_cvt_pk_bf16_f32 v165, v165, v165
    s_nop 0
    v_and_b32_dpp v24, v164, v4 quad_perm:[0,0,0,0] row_mask:0xf bank_mask:0xf
    v_and_b32_dpp v25, v164, v5 quad_perm:[0,0,0,0] row_mask:0xf bank_mask:0xf
    v_and_b32_dpp v26, v164, v6 quad_perm:[0,0,0,0] row_mask:0xf bank_mask:0xf
    v_and_b32_dpp v27, v164, v7 quad_perm:[0,0,0,0] row_mask:0xf bank_mask:0xf
    v_and_b32_dpp v28, v164, v4 quad_perm:[1,1,1,1] row_mask:0xf bank_mask:0xf
    v_and_b32_dpp v29, v164, v5 quad_perm:[1,1,1,1] row_mask:0xf bank_mask:0xf
    v_and_b32_dpp v30, v164, v6 quad_perm:[1,1,1,1] row_mask:0xf bank_mask:0xf
    v_and_b32_dpp v31, v164, v7 quad_perm:[1,1,1,1] row_mask:0xf bank_mask:0xf
    v_mfma_f32_16x16x32_bf16 v[16:19], v[24:27], v[64:67], 0
    v_mfma_f32_16x16x32_bf16 v[20:23], v[24:27], v[68:71], 0
    v_and_b32_dpp v24, v164, v4 quad_perm:[2,2,2,2] row_mask:0xf bank_mask:0xf
    v_and_b32_dpp v25, v164, v5 quad_perm:[2,2,2,2] row_mask:0xf bank_mask:0xf
    v_and_b32_dpp v26, v164, v6 quad_perm:[2,2,2,2] row_mask:0xf bank_mask:0xf
    v_and_b32_dpp v27, v164, v7 quad_perm:[2,2,2,2] row_mask:0xf bank_mask:0xf
    v_mfma_f32_16x16x32_bf16 v[16:19], v[28:31], v[72:75], v[16:19]
    v_mfma_f32_16x16x32_bf16 v[20:23], v[28:31], v[76:79], v[20:23]
    v_and_b32_dpp v28, v164, v4 quad_perm:[3,3,3,3] row_mask:0xf bank_mask:0xf
    v_and_b32_dpp v29, v164, v5 quad_perm:[3,3,3,3] row_mask:0xf bank_mask:0xf
    v_and_b32_dpp v30, v164, v6 quad_perm:[3,3,3,3] row_mask:0xf bank_mask:0xf
    v_and_b32_dpp v31, v164, v7 quad_perm:[3,3,3,3] row_mask:0xf bank_mask:0xf
    v_mfma_f32_16x16x32_bf16 v[16:19], v[24:27], v[80:83], v[16:19]
    v_mfma_f32_16x16x32_bf16 v[20:23], v[24:27], v[84:87], v[20:23]
    v_and_b32_dpp v24, v165, v4 quad_perm:[0,0,0,0] row_mask:0xf bank_mask:0xf
    v_and_b32_dpp v25, v165, v5 quad_perm:[0,0,0,0] row_mask:0xf bank_mask:0xf
    v_and_b32_dpp v26, v165, v6 quad_perm:[0,0,0,0] row_mask:0xf bank_mask:0xf
    v_and_b32_dpp v27, v165, v7 quad_perm:[0,0,0,0] row_mask:0xf bank_mask:0xf
    v_mfma_f32_16x16x32_bf16 v[16:19], v[28:31], v[88:91], v[16:19]
    v_mfma_f32_16x16x32_bf16 v[20:23], v[28:31], v[92:95], v[20:23]
    v_and_b32_dpp v28, v165, v4 quad_perm:[1,1,1,1] row_mask:0xf bank_mask:0xf
    v_and_b32_dpp v29, v165, v5 quad_perm:[1,1,1,1] row_mask:0xf bank_mask:0xf
    v_and_b32_dpp v30, v165, v6 quad_perm:[1,1,1,1] row_mask:0xf bank_mask:0xf
    v_and_b32_dpp v31, v165, v7 quad_perm:[1,1,1,1] row_mask:0xf bank_mask:0xf
    s_waitcnt vmcnt(6)
    v_mfma_f32_16x16x32_bf16 v[16:19], v[24:27], v[96:99], v[16:19]
    v_mfma_f32_16x16x32_bf16 v[20:23], v[24:27], v[100:103], v[20:23]
    v_and_b32_dpp v24, v165, v4 quad_perm:[2,2,2,2] row_mask:0xf bank_mask:0xf
    v_and_b32_dpp v25, v165, v5 quad_perm:[2,2,2,2] row_mask:0xf bank_mask:0xf
    v_and_b32_dpp v26, v165, v6 quad_perm:[2,2,2,2] row_mask:0xf bank_mask:0xf
    v_and_b32_dpp v27, v165, v7 quad_perm:[2,2,2,2] row_mask:0xf bank_mask:0xf
    s_waitcnt vmcnt(4)
    v_mfma_f32_16x16x32_bf16 v[16:19], v[28:31], v[104:107], v[16:19]
    v_mfma_f32_16x16x32_bf16 v[20:23], v[28:31], v[108:111], v[20:23]
    v_and_b32_dpp v28, v165, v4 quad_perm:[3,3,3,3] row_mask:0xf bank_mask:0xf
    v_and_b32_dpp v29, v165, v5 quad_perm:[3,3,3,3] row_mask:0xf bank_mask:0xf
    v_and_b32_dpp v30, v165, v6 quad_perm:[3,3,3,3] row_mask:0xf bank_mask:0xf
    v_and_b32_dpp v31, v165, v7 quad_perm:[3,3,3,3] row_mask:0xf bank_mask:0xf
    s_waitcnt vmcnt(2)
    v_mfma_f32_16x16x32_bf16 v[16:19], v[24:27], v[112:115], v[16:19]
    v_mfma_f32_16x16x32_bf16 v[20:23], v[24:27], v[116:119], v[20:23]
    s_waitcnt vmcnt(0)
    v_mfma_f32_16x16x32_bf16 v[16:19], v[28:31], v[120:123], v[16:19]
    v_mfma_f32_16x16x32_bf16 v[20:23], v[28:31], v[124:127], v[20:23]
    s_nop 6
    ds_write_b128 v52, v[16:19] offset:14336
    ds_write_b128 v52, v[20:23] offset:15360
    s_mov_b64 exec, 1
    ds_add_rtn_u32 v58, v63, v59 offset:12
    s_mov_b64 exec, -1
    ds_read_b128 v[64:67], v61 offset:14336
    ds_read_b128 v[68:71], v61 offset:16384
    ds_read_b128 v[72:75], v61 offset:18432
    ds_read_b128 v[76:79], v61 offset:20480
    s_mov_b64 exec, 0xff
    ds_read_b128 v[80:83], v53 offset:14336
    ds_read_b128 v[84:87], v53 offset:16384
    ds_read_b128 v[88:91], v53 offset:18432
    ds_read_b128 v[92:95], v53 offset:20480
    s_mov_b64 exec, -1
    s_waitcnt lgkmcnt(8)
    v_readfirstlane_b32 s14, v58
    s_cmp_lg_u32 s14, 3
    s_cbranch_scc1 L_fin
    s_waitcnt lgkmcnt(6)
    v_pk_add_f32 v[64:65], v[64:65], v[68:69]
    v_pk_add_f32 v[66:67], v[66:67], v[70:71]
    s_waitcnt lgkmcnt(4)
    v_pk_add_f32 v[72:73], v[72:73], v[76:77]
    v_pk_add_f32 v[74:75], v[74:75], v[78:79]
    v_pk_add_f32 v[64:65], v[64:65], v[72:73]
    v_pk_add_f32 v[66:67], v[66:67], v[74:75]
    v_bfi_b32 v64, v62, s96, v64
    v_bfi_b32 v65, v62, s97, v65
    v_bfi_b32 v66, v62, s98, v66
    v_bfi_b32 v67, v62, s99, v67
    global_store_dwordx4 v51, v[64:67], s[42:43] offset:0 sc1
    s_mov_b64 exec, 0xff
    s_waitcnt lgkmcnt(2)
    v_pk_add_f32 v[80:81], v[80:81], v[84:85]
    v_pk_add_f32 v[82:83], v[82:83], v[86:87]
    s_waitcnt lgkmcnt(0)
    v_pk_add_f32 v[88:89], v[88:89], v[92:93]
    v_pk_add_f32 v[90:91], v[90:91], v[94:95]
    v_pk_add_f32 v[80:81], v[80:81], v[88:89]
    v_pk_add_f32 v[82:83], v[82:83], v[90:91]
    v_bfi_b32 v80, v62, s96, v80
    v_bfi_b32 v81, v62, s97, v81
    v_bfi_b32 v82, v62, s98, v82
    v_bfi_b32 v83, v62, s99, v83
    global_store_dwordx4 v51, v[80:83], s[42:43] offset:1024 sc1
    ds_write_b32 v63, v59 offset:16
L_fin:
L_end:
    s_endpgm
.section .rodata,"a"
.p2align 6
.amdhsa_kernel gated_mix__sliding_block_cached__gqa_block_cached__decode_kernel
  .amdhsa_next_free_vgpr 256
  .amdhsa_next_free_sgpr 102
  .amdhsa_accum_offset 256
  .amdhsa_group_segment_fixed_size 0
  .amdhsa_kernarg_size 112
  .amdhsa_user_sgpr_count 2
  .amdhsa_user_sgpr_kernarg_segment_ptr 1
  .amdhsa_system_sgpr_workgroup_id_x 1
.end_amdhsa_kernel
```
